```python
import torch

def _softmax(x, axis=-1):
    return torch.softmax(x, dim=axis)

def _gelu(x):
    return torch.nn.functional.gelu(x, approximate='tanh')

def _silu(x):
    return torch.nn.functional.silu(x)

def _sigmoid(x):
    return torch.sigmoid(x)

def _layernorm(x, axis=-1, eps=1e-05):
    m = x.mean(dim=axis, keepdim=True)
    v = x.var(dim=axis, keepdim=True, unbiased=False)
    return (x - m) / torch.sqrt(v + eps)

def _scatter_add(tgt, idx, src, axis=0):
    return tgt.clone().index_add_(axis, idx, src)

def _segment_sum(src, seg, n):
    out = torch.zeros((n,) + src.shape[1:], dtype=src.dtype)
    return out.index_add_(0, seg, src)

def _pad(x, pw):
    flat = tuple((v for pair in reversed(pw) for v in pair))
    return torch.nn.functional.pad(x, flat)
kernel_name = 'adaLN_cond__ssm_conv_s4__mixer_channel_mlp__prompt'

def setup_inputs():

    _w = lambda a: (lambda t: t.to(torch.bfloat16) if t.is_floating_point() else t)(torch.as_tensor(a))

    def _A_setup():
        B, L, D, N = (1, 2048, 576, 128)
        A_re = -(lambda _x: torch.exp(torch.as_tensor(_x)))((lambda *s: torch.randn(*s, dtype=torch.bfloat16) * 3.2)(D, N))
        A_im = torch.pi * (lambda *s: torch.randn(*s, dtype=torch.bfloat16) * 0.05)(D, N)
        B_re = (lambda *s: torch.randn(*s, dtype=torch.bfloat16) * 0.1)(D, N)
        B_im = (lambda *s: torch.randn(*s, dtype=torch.bfloat16) * 0.1)(D, N)
        C_re = (lambda *s: torch.randn(*s, dtype=torch.bfloat16) * 0.1)(D, N)
        C_im = (lambda *s: torch.randn(*s, dtype=torch.bfloat16) * 0.1)(D, N)
        log_dt = (lambda *s: torch.randn(*s, dtype=torch.bfloat16) * 0.05)(D) * 0.5 - 4.0
        Dskip = (lambda *s: torch.randn(*s, dtype=torch.bfloat16) * 0.05)(D)
        return {'u': _w((lambda *s: torch.randn(*s, dtype=torch.bfloat16) * 0.05)(B, L, D)), 'A_re': _w(A_re), 'A_im': _w(A_im), 'B_re': _w(B_re), 'B_im': _w(B_im), 'C_re': _w(C_re), 'C_im': _w(C_im), 'log_dt': _w(log_dt), 'Dskip': _w(Dskip)}
    _A_in = _A_setup()

    def _B_setup():
        B, S, D, F = (1, 2048, 576, 4608)
        return {'x': _w((lambda *s: torch.randn(*s, dtype=torch.bfloat16) * 0.05)(B, S, D)), 'w1': _w((lambda *s: torch.randn(*s, dtype=torch.bfloat16) * 3.2)(D, F) * D ** (-0.5)), 'b1': _w((lambda *s: torch.randn(*s, dtype=torch.bfloat16) * 1.6)(F)), 'w2': _w((lambda *s: torch.randn(*s, dtype=torch.bfloat16) * 0.8)(F, D) * F ** (-0.5)), 'b2': _w((lambda *s: torch.randn(*s, dtype=torch.bfloat16) * 0.8)(D))}
    _B_in = _B_setup()
    return {'A_u': _A_in['u'], 'A_A_re': _A_in['A_re'], 'A_A_im': _A_in['A_im'], 'A_B_re': _A_in['B_re'], 'A_B_im': _A_in['B_im'], 'A_C_re': _A_in['C_re'], 'A_C_im': _A_in['C_im'], 'A_log_dt': _A_in['log_dt'], 'A_Dskip': _A_in['Dskip'], 'B_x': _B_in['x'], 'B_w1': _B_in['w1'], 'B_b1': _B_in['b1'], 'B_w2': _B_in['w2'], 'B_b2': _B_in['b2'], 'c': _w((lambda *s: torch.randn(*s, dtype=torch.bfloat16) * 0.2)(1, 576) * 8.0), 'w_mod': _w((lambda *s: torch.randn(*s, dtype=torch.bfloat16) * 0.2)(576, 6 * 576) * 576 ** (-0.5) * 8.0)}

def reference(A_u, A_A_re, A_A_im, A_B_re, A_B_im, A_C_re, A_C_im, A_log_dt, A_Dskip, B_x, B_w1, B_b1, B_w2, B_b2, c, w_mod):

    def _A_ref(u, A_re, A_im, B_re, B_im, C_re, C_im, log_dt, Dskip):
        Bsz, L, D = u.shape
        dt = torch.exp(log_dt)[:, None]
        A = A_re + 1j * A_im
        Bc = B_re + 1j * B_im
        Cc = C_re + 1j * C_im
        logdA = dt * A
        dB = dt * Bc
        l = (lambda x, dt: x.to(dt))(torch.arange(L), A_re.dtype)
        P = torch.exp(logdA[:, :, None] * l[None, None, :])
        K = torch.einsum('dn,dnl,dn->dl', Cc, P, dB).real
        L2 = 2 * L
        Kp = _pad(K, ((0, 0), (0, L)))
        up = (lambda x, *d: x.permute(*d))(u, 0, 2, 1)
        up = _pad(up, ((0, 0), (0, 0), (0, L)))
        Kf = (lambda x, axes=(-2, -1): torch.fft.rfft2(x.float(), dim=axes))(Kp[:, None, :], axes=(-2, -1))
        Uf = (lambda x, axes=(-2, -1): torch.fft.rfft2(x.float(), dim=axes))(up[:, :, None, :], axes=(-2, -1))
        Yf = Uf * Kf[None, :, :, :]
        y = (lambda x, s, axes=(-2, -1): torch.fft.irfft2(x, s=s, dim=axes).to(torch.bfloat16))(Yf, (1, L2), axes=(-2, -1))[:, :, 0, :L]
        y = (lambda x, *d: x.permute(*d))(y, 0, 2, 1) + u * Dskip[None, None, :]
        return y

    def _B_ref(x, w1, b1, w2, b2):
        y = _layernorm(x, axis=-1)
        h = _gelu(torch.einsum('bsd,df->bsf', y, w1) + b1)
        return torch.einsum('bsf,fd->bsd', h, w2) + b2
    x = A_u
    mod = (_silu(c) @ w_mod).reshape(c.shape[0], 6, 1, -1)
    sa, ca, ga, sb, cb, gb = (mod[:, 0].clone(), mod[:, 1].clone(), mod[:, 2].clone(), mod[:, 3].clone(), mod[:, 4].clone(), mod[:, 5].clone())
    h = _layernorm(x, axis=-1) * (1 + ca) + sa
    x = x + ga * _A_ref(h, A_A_re, A_A_im, A_B_re, A_B_im, A_C_re, A_C_im, A_log_dt, A_Dskip)
    h = _layernorm(x, axis=-1) * (1 + cb) + sb
    x = x + gb * _B_ref(h, B_w1, B_b1, B_w2, B_b2)
    return x
```

```asm
; @launch kernel=front_kernel grid=(728,1,1) block=(256,1,1) lds=39680
; @launch kernel=mlp_kernel grid=(256,1,1) block=(768,1,1) lds=156736
.amdgcn_target "amdgcn-amd-amdhsa--gfx950"
.text
.globl front_kernel
.p2align 8
.type front_kernel,@function
front_kernel:
    s_cmp_ge_u32 s2, 728
    s_cbranch_scc1 A_done
    s_load_dwordx4 s[20:23], s[0:1], 136
    v_lshrrev_b32 v8, 6, v0
    s_nop 0
    v_readfirstlane_b32 s75, v8
    v_and_b32 v7, 63, v0
    s_cmp_ge_u32 s2, 152
    s_cbranch_scc1 A_conv
    s_cmp_ge_u32 s2, 64
    s_cbranch_scc1 A_mod
    s_load_dwordx2 s[26:27], s[0:1], 0
    s_mul_i32 s24, s2, 36864
    v_lshrrev_b32 v5, 3, v0
    v_and_b32 v6, 7, v0
    v_mul_u32_u24 v1, 1152, v5
    v_lshl_add_u32 v1, v6, 4, v1
    s_waitcnt lgkmcnt(0)
    s_mov_b32 s8, s26
    s_and_b32 s9, s27, 0xffff
    s_mov_b32 s10, 2359296
    s_mov_b32 s11, 0x20000
    buffer_load_dwordx4 v[10:13], v1, s[8:11], s24 offen offset:0
    buffer_load_dwordx4 v[14:17], v1, s[8:11], s24 offen offset:128
    buffer_load_dwordx4 v[18:21], v1, s[8:11], s24 offen offset:256
    buffer_load_dwordx4 v[22:25], v1, s[8:11], s24 offen offset:384
    buffer_load_dwordx4 v[26:29], v1, s[8:11], s24 offen offset:512
    buffer_load_dwordx4 v[30:33], v1, s[8:11], s24 offen offset:640
    buffer_load_dwordx4 v[34:37], v1, s[8:11], s24 offen offset:768
    buffer_load_dwordx4 v[38:41], v1, s[8:11], s24 offen offset:896
    buffer_load_dwordx4 v[42:45], v1, s[8:11], s24 offen offset:1024
    s_mov_b32 s4, s22
    s_and_b32 s5, s23, 0xffff
    s_mov_b32 s6, 268435456
    s_mov_b32 s7, 0x20000
    s_mov_b32 s16, s20
    s_and_b32 s17, s21, 0xffff
    s_mov_b32 s18, 256
    s_mov_b32 s19, 0x20000
    s_or_b32 s25, s2, s75
    s_cmp_lg_u32 s25, 0
    s_cbranch_scc1 A_notag
    s_memrealtime s[68:69]
    v_mov_b32 v2, 0
    s_waitcnt lgkmcnt(0)
    s_or_b32 s68, s68, 1
    v_mov_b32 v3, s68
    buffer_store_dword v3, v2, s[16:19], 0 offen sc1
A_notag:
    s_getpc_b64 s[28:29]
A_pc:
    s_sub_u32 s28, s28, A_pc - front_kernel
    s_subb_u32 s29, s29, 0
    v_min_u32 v2, (text_end - front_kernel - 4) / 128, v0
    v_lshlrev_b32 v2, 7, v2
    global_load_dword v125, v2, s[28:29]
    v_and_b32 v2, 31, v0
    v_lshlrev_b32 v2, 2, v2
    v_mov_b32 v3, 0
    s_lshl_b32 s25, s2, 7
    s_add_u32 s25, s25, 81920
    buffer_store_dword v3, v2, s[4:7], s25 offen
    v_mul_u32_u24 v2, 1184, v5
    v_lshl_add_u32 v2, v6, 4, v2
    v_lshrrev_b32 v9, 4, v7
    v_bfe_u32 v46, v7, 2, 2
    v_lshl_add_u32 v46, v9, 3, v46
    v_mul_u32_u24 v3, 1184, v46
    v_and_b32 v46, 3, v7
    v_lshl_add_u32 v3, v46, 3, v3
    v_lshl_add_u32 v3, v8, 5, v3
    v_and_b32 v46, 15, v7
    v_lshlrev_b32 v4, 6, v46
    v_lshl_add_u32 v4, v9, 4, v4
    v_lshl_add_u32 v4, v8, 10, v4
    s_mov_b32 s25, 0x3f803f80
    v_mov_b32 v46, 0
    v_mov_b32 v47, 0
    v_mov_b32 v48, 0
    v_mov_b32 v49, 0
    s_waitcnt vmcnt(10)
    ds_write_b128 v2, v[10:13] offset:0
    v_dot2_f32_bf16 v46, v10, s25, v46
    v_dot2_f32_bf16 v47, v11, s25, v47
    v_dot2_f32_bf16 v46, v12, s25, v46
    v_dot2_f32_bf16 v47, v13, s25, v47
    v_dot2_f32_bf16 v48, v10, v10, v48
    v_dot2_f32_bf16 v49, v11, v11, v49
    v_dot2_f32_bf16 v48, v12, v12, v48
    v_dot2_f32_bf16 v49, v13, v13, v49
    s_waitcnt vmcnt(9)
    ds_write_b128 v2, v[14:17] offset:128
    v_dot2_f32_bf16 v46, v14, s25, v46
    v_dot2_f32_bf16 v47, v15, s25, v47
    v_dot2_f32_bf16 v46, v16, s25, v46
    v_dot2_f32_bf16 v47, v17, s25, v47
    v_dot2_f32_bf16 v48, v14, v14, v48
    v_dot2_f32_bf16 v49, v15, v15, v49
    v_dot2_f32_bf16 v48, v16, v16, v48
    v_dot2_f32_bf16 v49, v17, v17, v49
    s_waitcnt vmcnt(8)
    ds_write_b128 v2, v[18:21] offset:256
    v_dot2_f32_bf16 v46, v18, s25, v46
    v_dot2_f32_bf16 v47, v19, s25, v47
    v_dot2_f32_bf16 v46, v20, s25, v46
    v_dot2_f32_bf16 v47, v21, s25, v47
    v_dot2_f32_bf16 v48, v18, v18, v48
    v_dot2_f32_bf16 v49, v19, v19, v49
    v_dot2_f32_bf16 v48, v20, v20, v48
    v_dot2_f32_bf16 v49, v21, v21, v49
    s_waitcnt vmcnt(7)
    ds_write_b128 v2, v[22:25] offset:384
    v_dot2_f32_bf16 v46, v22, s25, v46
    v_dot2_f32_bf16 v47, v23, s25, v47
    v_dot2_f32_bf16 v46, v24, s25, v46
    v_dot2_f32_bf16 v47, v25, s25, v47
    v_dot2_f32_bf16 v48, v22, v22, v48
    v_dot2_f32_bf16 v49, v23, v23, v49
    v_dot2_f32_bf16 v48, v24, v24, v48
    v_dot2_f32_bf16 v49, v25, v25, v49
    s_waitcnt vmcnt(6)
    ds_write_b128 v2, v[26:29] offset:512
    v_dot2_f32_bf16 v46, v26, s25, v46
    v_dot2_f32_bf16 v47, v27, s25, v47
    v_dot2_f32_bf16 v46, v28, s25, v46
    v_dot2_f32_bf16 v47, v29, s25, v47
    v_dot2_f32_bf16 v48, v26, v26, v48
    v_dot2_f32_bf16 v49, v27, v27, v49
    v_dot2_f32_bf16 v48, v28, v28, v48
    v_dot2_f32_bf16 v49, v29, v29, v49
    s_waitcnt vmcnt(5)
    ds_write_b128 v2, v[30:33] offset:640
    v_dot2_f32_bf16 v46, v30, s25, v46
    v_dot2_f32_bf16 v47, v31, s25, v47
    v_dot2_f32_bf16 v46, v32, s25, v46
    v_dot2_f32_bf16 v47, v33, s25, v47
    v_dot2_f32_bf16 v48, v30, v30, v48
    v_dot2_f32_bf16 v49, v31, v31, v49
    v_dot2_f32_bf16 v48, v32, v32, v48
    v_dot2_f32_bf16 v49, v33, v33, v49
    s_waitcnt vmcnt(4)
    ds_write_b128 v2, v[34:37] offset:768
    v_dot2_f32_bf16 v46, v34, s25, v46
    v_dot2_f32_bf16 v47, v35, s25, v47
    v_dot2_f32_bf16 v46, v36, s25, v46
    v_dot2_f32_bf16 v47, v37, s25, v47
    v_dot2_f32_bf16 v48, v34, v34, v48
    v_dot2_f32_bf16 v49, v35, v35, v49
    v_dot2_f32_bf16 v48, v36, v36, v48
    v_dot2_f32_bf16 v49, v37, v37, v49
    s_waitcnt vmcnt(3)
    ds_write_b128 v2, v[38:41] offset:896
    v_dot2_f32_bf16 v46, v38, s25, v46
    v_dot2_f32_bf16 v47, v39, s25, v47
    v_dot2_f32_bf16 v46, v40, s25, v46
    v_dot2_f32_bf16 v47, v41, s25, v47
    v_dot2_f32_bf16 v48, v38, v38, v48
    v_dot2_f32_bf16 v49, v39, v39, v49
    v_dot2_f32_bf16 v48, v40, v40, v48
    v_dot2_f32_bf16 v49, v41, v41, v49
    s_waitcnt vmcnt(2)
    ds_write_b128 v2, v[42:45] offset:1024
    v_dot2_f32_bf16 v46, v42, s25, v46
    v_dot2_f32_bf16 v47, v43, s25, v47
    v_dot2_f32_bf16 v46, v44, s25, v46
    v_dot2_f32_bf16 v47, v45, s25, v47
    v_dot2_f32_bf16 v48, v42, v42, v48
    v_dot2_f32_bf16 v49, v43, v43, v49
    v_dot2_f32_bf16 v48, v44, v44, v48
    v_dot2_f32_bf16 v49, v45, v45, v49
    s_waitcnt lgkmcnt(0)
    s_barrier
    ds_read_b64_tr_b16 v[50:51], v3 offset:0
    ds_read_b64_tr_b16 v[52:53], v3 offset:4736
    ds_read_b64_tr_b16 v[54:55], v3 offset:128
    ds_read_b64_tr_b16 v[56:57], v3 offset:4864
    ds_read_b64_tr_b16 v[58:59], v3 offset:256
    ds_read_b64_tr_b16 v[60:61], v3 offset:4992
    ds_read_b64_tr_b16 v[62:63], v3 offset:384
    ds_read_b64_tr_b16 v[64:65], v3 offset:5120
    ds_read_b64_tr_b16 v[66:67], v3 offset:512
    ds_read_b64_tr_b16 v[68:69], v3 offset:5248
    ds_read_b64_tr_b16 v[70:71], v3 offset:640
    ds_read_b64_tr_b16 v[72:73], v3 offset:5376
    ds_read_b64_tr_b16 v[74:75], v3 offset:768
    ds_read_b64_tr_b16 v[76:77], v3 offset:5504
    ds_read_b64_tr_b16 v[78:79], v3 offset:896
    ds_read_b64_tr_b16 v[80:81], v3 offset:5632
    ds_read_b64_tr_b16 v[82:83], v3 offset:1024
    ds_read_b64_tr_b16 v[84:85], v3 offset:5760
    v_add_f32 v46, v46, v47
    v_add_f32 v47, v48, v49
    s_nop 0
    v_add_f32_dpp v46, v46, v46 quad_perm:[1,0,3,2] row_mask:0xf bank_mask:0xf
    v_add_f32_dpp v47, v47, v47 quad_perm:[1,0,3,2] row_mask:0xf bank_mask:0xf
    s_nop 0
    v_add_f32_dpp v46, v46, v46 quad_perm:[2,3,0,1] row_mask:0xf bank_mask:0xf
    v_add_f32_dpp v47, v47, v47 quad_perm:[2,3,0,1] row_mask:0xf bank_mask:0xf
    s_nop 0
    v_add_f32_dpp v46, v46, v46 row_half_mirror row_mask:0xf bank_mask:0xf
    v_add_f32_dpp v47, v47, v47 row_half_mirror row_mask:0xf bank_mask:0xf
    v_mul_f32 v46, 0x3ae38e39, v46
    v_mul_f32 v47, 0x3ae38e39, v47
    v_fma_f32 v47, -v46, v46, v47
    v_max_f32 v47, 0, v47
    v_cvt_pk_bf16_f32 v47, v47, v47
    v_and_b32 v47, 0xffff0000, v47
    v_add_f32 v47, 0x3727c5ac, v47
    v_cvt_pk_bf16_f32 v47, v47, v47
    v_and_b32 v47, 0xffff0000, v47
    v_sqrt_f32 v47, v47
    s_nop 0
    v_cvt_pk_bf16_f32 v46, v47, v46
    v_lshlrev_b32 v48, 2, v5
    s_lshl_b32 s25, s2, 7
    s_add_u32 s25, s25, 32768
    v_cmp_eq_u32 vcc, 0, v6
    s_nop 0
    s_and_saveexec_b64 s[68:69], vcc
    buffer_store_dword v46, v48, s[4:7], s25 offen sc1
    s_mov_b64 exec, -1
    v_mov_b32 v9, 0
    buffer_load_dword v9, v9, s[16:19], 0 offen sc1
    s_add_u32 s25, s24, 131072
    s_waitcnt lgkmcnt(15)
    buffer_store_dwordx4 v[50:53], v4, s[4:7], s25 offen sc1
    s_add_u32 s25, s25, 4096
    s_waitcnt lgkmcnt(14)
    buffer_store_dwordx4 v[54:57], v4, s[4:7], s25 offen sc1
    s_add_u32 s25, s25, 4096
    s_waitcnt lgkmcnt(12)
    buffer_store_dwordx4 v[58:61], v4, s[4:7], s25 offen sc1
    s_add_u32 s25, s25, 4096
    s_waitcnt lgkmcnt(10)
    buffer_store_dwordx4 v[62:65], v4, s[4:7], s25 offen sc1
    s_add_u32 s25, s25, 4096
    s_waitcnt lgkmcnt(8)
    buffer_store_dwordx4 v[66:69], v4, s[4:7], s25 offen sc1
    s_add_u32 s25, s25, 4096
    s_waitcnt lgkmcnt(6)
    buffer_store_dwordx4 v[70:73], v4, s[4:7], s25 offen sc1
    s_add_u32 s25, s25, 4096
    s_waitcnt lgkmcnt(4)
    buffer_store_dwordx4 v[74:77], v4, s[4:7], s25 offen sc1
    s_add_u32 s25, s25, 4096
    s_waitcnt lgkmcnt(2)
    buffer_store_dwordx4 v[78:81], v4, s[4:7], s25 offen sc1
    s_add_u32 s25, s25, 4096
    s_waitcnt lgkmcnt(0)
    buffer_store_dwordx4 v[82:85], v4, s[4:7], s25 offen sc1
    s_waitcnt vmcnt(0)
    s_barrier
    s_cmp_lg_u32 s75, 0
    s_cbranch_scc1 sig_1
    s_mov_b64 exec, 1
    v_mov_b32 v1, 0
    s_mov_b32 s70, 1048576
tg_2:
    v_readfirstlane_b32 s71, v9
    s_nop 0
    s_cmp_lg_u32 s71, 0
    s_cbranch_scc1 tgd_3
    s_sub_u32 s70, s70, 1
    s_cmp_eq_u32 s70, 0
    s_cbranch_scc1 tgd_3
    buffer_load_dword v9, v1, s[16:19], 0 offen sc1
    s_waitcnt vmcnt(0)
    s_branch tg_2
tgd_3:
    s_lshl_b32 s71, s2, 2
    s_add_u32 s71, s71, 90112
    buffer_store_dword v9, v1, s[4:7], s71 offen sc1
    s_mov_b64 exec, -1
sig_1:
    s_endpgm
A_mod:
    s_sub_u32 s3, s2, 64
    s_sub_u32 s40, s3, 54
    s_cmp_lt_u32 s40, 2
    s_cbranch_scc1 A_coll
    s_cmp_ge_u32 s3, 83
    s_cbranch_scc1 A_done
    s_load_dwordx4 s[24:27], s[0:1], 112
    v_lshrrev_b32 v5, 3, v0
    v_and_b32 v6, 7, v0
    v_mul_u32_u24 v1, 6912, v5
    v_lshl_add_u32 v1, v6, 4, v1
    s_and_b32 s30, s3, 1
    s_lshr_b32 s41, s3, 1
    s_sub_u32 s40, s3, 29
    s_cmp_ge_u32 s3, 56
    s_cselect_b32 s3, s40, s41
    s_cselect_b32 s30, 0, s30
    s_cselect_b32 s40, 2, 1
    s_mov_b32 s41, s40
    s_lshl_b32 s28, s3, 7
    s_mul_i32 s29, s30, 1990656
    s_add_u32 s28, s28, s29
    s_mul_i32 s31, s30, 576
    v_mov_b32 v110, 0
    v_mov_b32 v111, 0
    v_mov_b32 v112, 0
    v_mov_b32 v113, 0
    v_mov_b32 v114, 0
    v_mov_b32 v115, 0
    v_mov_b32 v116, 0
    v_mov_b32 v117, 0
    v_mov_b32 v2, 0
    s_waitcnt lgkmcnt(0)
    s_mov_b32 s8, s26
    s_and_b32 s9, s27, 0xffff
    s_mov_b32 s10, 3981312
    s_mov_b32 s11, 0x20000
    s_mov_b32 s12, s24
    s_and_b32 s13, s25, 0xffff
    s_mov_b32 s14, 1152
    s_mov_b32 s15, 0x20000
    s_mov_b32 s4, s22
    s_and_b32 s5, s23, 0xffff
    s_mov_b32 s6, 268435456
    s_mov_b32 s7, 0x20000
    s_mov_b32 s16, s20
    s_and_b32 s17, s21, 0xffff
    s_mov_b32 s18, 256
    s_mov_b32 s19, 0x20000
    v_lshlrev_b32 v2, 1, v5
A_mpass:
    buffer_load_dwordx4 v[10:13], v1, s[8:11], s28 offen
    s_add_u32 s28, s28, 221184
    buffer_load_dwordx4 v[14:17], v1, s[8:11], s28 offen
    s_add_u32 s28, s28, 221184
    buffer_load_dwordx4 v[18:21], v1, s[8:11], s28 offen
    s_add_u32 s28, s28, 221184
    buffer_load_dwordx4 v[22:25], v1, s[8:11], s28 offen
    s_add_u32 s28, s28, 221184
    buffer_load_dwordx4 v[26:29], v1, s[8:11], s28 offen
    s_add_u32 s28, s28, 221184
    buffer_load_dwordx4 v[30:33], v1, s[8:11], s28 offen
    s_add_u32 s28, s28, 221184
    buffer_load_dwordx4 v[34:37], v1, s[8:11], s28 offen
    s_add_u32 s28, s28, 221184
    buffer_load_dwordx4 v[38:41], v1, s[8:11], s28 offen
    s_add_u32 s28, s28, 221184
    buffer_load_dwordx4 v[42:45], v1, s[8:11], s28 offen
    s_add_u32 s28, s28, 221184
    buffer_load_ushort v70, v2, s[12:15], s31 offen offset:0
    buffer_load_ushort v72, v2, s[12:15], s31 offen offset:64
    buffer_load_ushort v74, v2, s[12:15], s31 offen offset:128
    buffer_load_ushort v76, v2, s[12:15], s31 offen offset:192
    buffer_load_ushort v78, v2, s[12:15], s31 offen offset:256
    buffer_load_ushort v80, v2, s[12:15], s31 offen offset:320
    buffer_load_ushort v82, v2, s[12:15], s31 offen offset:384
    buffer_load_ushort v84, v2, s[12:15], s31 offen offset:448
    buffer_load_ushort v86, v2, s[12:15], s31 offen offset:512
    s_add_u32 s31, s31, 576
    s_waitcnt vmcnt(0)
    v_lshlrev_b32 v70, 16, v70
    v_mul_f32 v100, 0xbfb8aa3b, v70
    v_lshlrev_b32 v72, 16, v72
    v_mul_f32 v101, 0xbfb8aa3b, v72
    v_lshlrev_b32 v74, 16, v74
    v_mul_f32 v102, 0xbfb8aa3b, v74
    v_lshlrev_b32 v76, 16, v76
    v_mul_f32 v103, 0xbfb8aa3b, v76
    v_lshlrev_b32 v78, 16, v78
    v_mul_f32 v104, 0xbfb8aa3b, v78
    v_lshlrev_b32 v80, 16, v80
    v_mul_f32 v105, 0xbfb8aa3b, v80
    v_lshlrev_b32 v82, 16, v82
    v_mul_f32 v106, 0xbfb8aa3b, v82
    v_lshlrev_b32 v84, 16, v84
    v_mul_f32 v107, 0xbfb8aa3b, v84
    v_lshlrev_b32 v86, 16, v86
    v_mul_f32 v108, 0xbfb8aa3b, v86
    v_exp_f32 v100, v100
    v_exp_f32 v101, v101
    v_exp_f32 v102, v102
    v_exp_f32 v103, v103
    v_exp_f32 v104, v104
    v_exp_f32 v105, v105
    v_exp_f32 v106, v106
    v_exp_f32 v107, v107
    v_exp_f32 v108, v108
    v_add_f32 v100, 1.0, v100
    v_add_f32 v101, 1.0, v101
    v_add_f32 v102, 1.0, v102
    v_add_f32 v103, 1.0, v103
    v_add_f32 v104, 1.0, v104
    v_add_f32 v105, 1.0, v105
    v_add_f32 v106, 1.0, v106
    v_add_f32 v107, 1.0, v107
    v_add_f32 v108, 1.0, v108
    v_rcp_f32 v100, v100
    v_rcp_f32 v101, v101
    v_rcp_f32 v102, v102
    v_rcp_f32 v103, v103
    v_rcp_f32 v104, v104
    v_rcp_f32 v105, v105
    v_rcp_f32 v106, v106
    v_rcp_f32 v107, v107
    v_rcp_f32 v108, v108
    v_mul_f32 v70, v70, v100
    v_mul_f32 v72, v72, v101
    v_mul_f32 v74, v74, v102
    v_mul_f32 v76, v76, v103
    v_mul_f32 v78, v78, v104
    v_mul_f32 v80, v80, v105
    v_mul_f32 v82, v82, v106
    v_mul_f32 v84, v84, v107
    v_mul_f32 v86, v86, v108
    v_cvt_pk_bf16_f32 v70, v70, v70
    v_and_b32 v70, 0xffff0000, v70
    v_cvt_pk_bf16_f32 v72, v72, v72
    v_and_b32 v72, 0xffff0000, v72
    v_cvt_pk_bf16_f32 v74, v74, v74
    v_and_b32 v74, 0xffff0000, v74
    v_cvt_pk_bf16_f32 v76, v76, v76
    v_and_b32 v76, 0xffff0000, v76
    v_cvt_pk_bf16_f32 v78, v78, v78
    v_and_b32 v78, 0xffff0000, v78
    v_cvt_pk_bf16_f32 v80, v80, v80
    v_and_b32 v80, 0xffff0000, v80
    v_cvt_pk_bf16_f32 v82, v82, v82
    v_and_b32 v82, 0xffff0000, v82
    v_cvt_pk_bf16_f32 v84, v84, v84
    v_and_b32 v84, 0xffff0000, v84
    v_cvt_pk_bf16_f32 v86, v86, v86
    v_and_b32 v86, 0xffff0000, v86
    v_lshlrev_b32 v50, 16, v10
    v_and_b32 v51, 0xffff0000, v10
    v_lshlrev_b32 v52, 16, v11
    v_and_b32 v53, 0xffff0000, v11
    v_lshlrev_b32 v54, 16, v12
    v_and_b32 v55, 0xffff0000, v12
    v_lshlrev_b32 v56, 16, v13
    v_and_b32 v57, 0xffff0000, v13
    v_pk_fma_f32 v[110:111], v[50:51], v[70:71], v[110:111] op_sel_hi:[1,0,1]
    v_pk_fma_f32 v[112:113], v[52:53], v[70:71], v[112:113] op_sel_hi:[1,0,1]
    v_pk_fma_f32 v[114:115], v[54:55], v[70:71], v[114:115] op_sel_hi:[1,0,1]
    v_pk_fma_f32 v[116:117], v[56:57], v[70:71], v[116:117] op_sel_hi:[1,0,1]
    v_lshlrev_b32 v50, 16, v14
    v_and_b32 v51, 0xffff0000, v14
    v_lshlrev_b32 v52, 16, v15
    v_and_b32 v53, 0xffff0000, v15
    v_lshlrev_b32 v54, 16, v16
    v_and_b32 v55, 0xffff0000, v16
    v_lshlrev_b32 v56, 16, v17
    v_and_b32 v57, 0xffff0000, v17
    v_pk_fma_f32 v[110:111], v[50:51], v[72:73], v[110:111] op_sel_hi:[1,0,1]
    v_pk_fma_f32 v[112:113], v[52:53], v[72:73], v[112:113] op_sel_hi:[1,0,1]
    v_pk_fma_f32 v[114:115], v[54:55], v[72:73], v[114:115] op_sel_hi:[1,0,1]
    v_pk_fma_f32 v[116:117], v[56:57], v[72:73], v[116:117] op_sel_hi:[1,0,1]
    v_lshlrev_b32 v50, 16, v18
    v_and_b32 v51, 0xffff0000, v18
    v_lshlrev_b32 v52, 16, v19
    v_and_b32 v53, 0xffff0000, v19
    v_lshlrev_b32 v54, 16, v20
    v_and_b32 v55, 0xffff0000, v20
    v_lshlrev_b32 v56, 16, v21
    v_and_b32 v57, 0xffff0000, v21
    v_pk_fma_f32 v[110:111], v[50:51], v[74:75], v[110:111] op_sel_hi:[1,0,1]
    v_pk_fma_f32 v[112:113], v[52:53], v[74:75], v[112:113] op_sel_hi:[1,0,1]
    v_pk_fma_f32 v[114:115], v[54:55], v[74:75], v[114:115] op_sel_hi:[1,0,1]
    v_pk_fma_f32 v[116:117], v[56:57], v[74:75], v[116:117] op_sel_hi:[1,0,1]
    v_lshlrev_b32 v50, 16, v22
    v_and_b32 v51, 0xffff0000, v22
    v_lshlrev_b32 v52, 16, v23
    v_and_b32 v53, 0xffff0000, v23
    v_lshlrev_b32 v54, 16, v24
    v_and_b32 v55, 0xffff0000, v24
    v_lshlrev_b32 v56, 16, v25
    v_and_b32 v57, 0xffff0000, v25
    v_pk_fma_f32 v[110:111], v[50:51], v[76:77], v[110:111] op_sel_hi:[1,0,1]
    v_pk_fma_f32 v[112:113], v[52:53], v[76:77], v[112:113] op_sel_hi:[1,0,1]
    v_pk_fma_f32 v[114:115], v[54:55], v[76:77], v[114:115] op_sel_hi:[1,0,1]
    v_pk_fma_f32 v[116:117], v[56:57], v[76:77], v[116:117] op_sel_hi:[1,0,1]
    v_lshlrev_b32 v50, 16, v26
    v_and_b32 v51, 0xffff0000, v26
    v_lshlrev_b32 v52, 16, v27
    v_and_b32 v53, 0xffff0000, v27
    v_lshlrev_b32 v54, 16, v28
    v_and_b32 v55, 0xffff0000, v28
    v_lshlrev_b32 v56, 16, v29
    v_and_b32 v57, 0xffff0000, v29
    v_pk_fma_f32 v[110:111], v[50:51], v[78:79], v[110:111] op_sel_hi:[1,0,1]
    v_pk_fma_f32 v[112:113], v[52:53], v[78:79], v[112:113] op_sel_hi:[1,0,1]
    v_pk_fma_f32 v[114:115], v[54:55], v[78:79], v[114:115] op_sel_hi:[1,0,1]
    v_pk_fma_f32 v[116:117], v[56:57], v[78:79], v[116:117] op_sel_hi:[1,0,1]
    v_lshlrev_b32 v50, 16, v30
    v_and_b32 v51, 0xffff0000, v30
    v_lshlrev_b32 v52, 16, v31
    v_and_b32 v53, 0xffff0000, v31
    v_lshlrev_b32 v54, 16, v32
    v_and_b32 v55, 0xffff0000, v32
    v_lshlrev_b32 v56, 16, v33
    v_and_b32 v57, 0xffff0000, v33
    v_pk_fma_f32 v[110:111], v[50:51], v[80:81], v[110:111] op_sel_hi:[1,0,1]
    v_pk_fma_f32 v[112:113], v[52:53], v[80:81], v[112:113] op_sel_hi:[1,0,1]
    v_pk_fma_f32 v[114:115], v[54:55], v[80:81], v[114:115] op_sel_hi:[1,0,1]
    v_pk_fma_f32 v[116:117], v[56:57], v[80:81], v[116:117] op_sel_hi:[1,0,1]
    v_lshlrev_b32 v50, 16, v34
    v_and_b32 v51, 0xffff0000, v34
    v_lshlrev_b32 v52, 16, v35
    v_and_b32 v53, 0xffff0000, v35
    v_lshlrev_b32 v54, 16, v36
    v_and_b32 v55, 0xffff0000, v36
    v_lshlrev_b32 v56, 16, v37
    v_and_b32 v57, 0xffff0000, v37
    v_pk_fma_f32 v[110:111], v[50:51], v[82:83], v[110:111] op_sel_hi:[1,0,1]
    v_pk_fma_f32 v[112:113], v[52:53], v[82:83], v[112:113] op_sel_hi:[1,0,1]
    v_pk_fma_f32 v[114:115], v[54:55], v[82:83], v[114:115] op_sel_hi:[1,0,1]
    v_pk_fma_f32 v[116:117], v[56:57], v[82:83], v[116:117] op_sel_hi:[1,0,1]
    v_lshlrev_b32 v50, 16, v38
    v_and_b32 v51, 0xffff0000, v38
    v_lshlrev_b32 v52, 16, v39
    v_and_b32 v53, 0xffff0000, v39
    v_lshlrev_b32 v54, 16, v40
    v_and_b32 v55, 0xffff0000, v40
    v_lshlrev_b32 v56, 16, v41
    v_and_b32 v57, 0xffff0000, v41
    v_pk_fma_f32 v[110:111], v[50:51], v[84:85], v[110:111] op_sel_hi:[1,0,1]
    v_pk_fma_f32 v[112:113], v[52:53], v[84:85], v[112:113] op_sel_hi:[1,0,1]
    v_pk_fma_f32 v[114:115], v[54:55], v[84:85], v[114:115] op_sel_hi:[1,0,1]
    v_pk_fma_f32 v[116:117], v[56:57], v[84:85], v[116:117] op_sel_hi:[1,0,1]
    v_lshlrev_b32 v50, 16, v42
    v_and_b32 v51, 0xffff0000, v42
    v_lshlrev_b32 v52, 16, v43
    v_and_b32 v53, 0xffff0000, v43
    v_lshlrev_b32 v54, 16, v44
    v_and_b32 v55, 0xffff0000, v44
    v_lshlrev_b32 v56, 16, v45
    v_and_b32 v57, 0xffff0000, v45
    v_pk_fma_f32 v[110:111], v[50:51], v[86:87], v[110:111] op_sel_hi:[1,0,1]
    v_pk_fma_f32 v[112:113], v[52:53], v[86:87], v[112:113] op_sel_hi:[1,0,1]
    v_pk_fma_f32 v[114:115], v[54:55], v[86:87], v[114:115] op_sel_hi:[1,0,1]
    v_pk_fma_f32 v[116:117], v[56:57], v[86:87], v[116:117] op_sel_hi:[1,0,1]
    s_sub_u32 s41, s41, 1
    s_cmp_lg_u32 s41, 0
    s_cbranch_scc1 A_mpass
    v_lshlrev_b32 v3, 8, v5
    v_lshl_add_u32 v3, v6, 5, v3
    ds_write_b128 v3, v[110:113]
    ds_write_b128 v3, v[114:117] offset:16
    s_waitcnt lgkmcnt(0)
    s_barrier
    s_mov_b32 s91, s2
    s_cmp_lg_u32 s75, 0
    s_cbranch_scc1 A_done
    v_lshlrev_b32 v3, 2, v0
    v_mov_b32 v9, 0
    buffer_load_dword v9, v9, s[16:19], 0 offen sc1
    ds_read_b32 v10, v3 offset:0
    ds_read_b32 v11, v3 offset:256
    ds_read_b32 v12, v3 offset:512
    ds_read_b32 v13, v3 offset:768
    ds_read_b32 v14, v3 offset:1024
    ds_read_b32 v15, v3 offset:1280
    ds_read_b32 v16, v3 offset:1536
    ds_read_b32 v17, v3 offset:1792
    ds_read_b32 v18, v3 offset:2048
    ds_read_b32 v19, v3 offset:2304
    ds_read_b32 v20, v3 offset:2560
    ds_read_b32 v21, v3 offset:2816
    ds_read_b32 v22, v3 offset:3072
    ds_read_b32 v23, v3 offset:3328
    ds_read_b32 v24, v3 offset:3584
    ds_read_b32 v25, v3 offset:3840
    ds_read_b32 v26, v3 offset:4096
    ds_read_b32 v27, v3 offset:4352
    ds_read_b32 v28, v3 offset:4608
    ds_read_b32 v29, v3 offset:4864
    ds_read_b32 v30, v3 offset:5120
    ds_read_b32 v31, v3 offset:5376
    ds_read_b32 v32, v3 offset:5632
    ds_read_b32 v33, v3 offset:5888
    ds_read_b32 v34, v3 offset:6144
    ds_read_b32 v35, v3 offset:6400
    ds_read_b32 v36, v3 offset:6656
    ds_read_b32 v37, v3 offset:6912
    ds_read_b32 v38, v3 offset:7168
    ds_read_b32 v39, v3 offset:7424
    ds_read_b32 v40, v3 offset:7680
    ds_read_b32 v41, v3 offset:7936
    s_lshl_b32 s28, s3, 8
    s_mul_i32 s29, s30, 13824
    s_add_u32 s28, s28, s29
    s_add_u32 s28, s28, 49152
    s_waitcnt lgkmcnt(0)
    v_pk_add_f32 v[10:11], v[10:11], v[26:27]
    v_pk_add_f32 v[12:13], v[12:13], v[28:29]
    v_pk_add_f32 v[14:15], v[14:15], v[30:31]
    v_pk_add_f32 v[16:17], v[16:17], v[32:33]
    v_pk_add_f32 v[18:19], v[18:19], v[34:35]
    v_pk_add_f32 v[20:21], v[20:21], v[36:37]
    v_pk_add_f32 v[22:23], v[22:23], v[38:39]
    v_pk_add_f32 v[24:25], v[24:25], v[40:41]
    v_pk_add_f32 v[10:11], v[10:11], v[18:19]
    v_pk_add_f32 v[12:13], v[12:13], v[20:21]
    v_pk_add_f32 v[14:15], v[14:15], v[22:23]
    v_pk_add_f32 v[16:17], v[16:17], v[24:25]
    v_pk_add_f32 v[10:11], v[10:11], v[14:15]
    v_pk_add_f32 v[12:13], v[12:13], v[16:17]
    s_nop 0
    v_pk_add_f32 v[10:11], v[10:11], v[12:13]
    s_nop 0
    v_add_f32 v10, v10, v11
    s_cmp_eq_u32 s40, 1
    s_cbranch_scc1 A_mpart
    v_cvt_pk_bf16_f32 v10, v10, v10
    v_and_b32 v10, 0xffff0000, v10
    s_sub_u32 s29, s3, 36
    s_cmp_lt_u32 s29, 9
    s_cselect_b32 s29, 1.0, 0
    v_add_f32 v10, s29, v10
    v_cvt_pk_bf16_f32 v10, v10, v10
    v_and_b32 v10, 0xffff0000, v10
    s_lshl_b32 s28, s3, 8
    s_add_u32 s28, s28, 0
    buffer_store_dword v10, v3, s[4:7], s28 offen
    s_endpgm
A_mpart:
    buffer_store_dword v10, v3, s[4:7], s28 offen sc1
    s_waitcnt vmcnt(0)
    s_mov_b64 exec, 1
    v_mov_b32 v1, 0
    s_mov_b32 s70, 1048576
tg_4:
    v_readfirstlane_b32 s71, v9
    s_nop 0
    s_cmp_lg_u32 s71, 0
    s_cbranch_scc1 tgd_5
    s_sub_u32 s70, s70, 1
    s_cmp_eq_u32 s70, 0
    s_cbranch_scc1 tgd_5
    buffer_load_dword v9, v1, s[16:19], 0 offen sc1
    s_waitcnt vmcnt(0)
    s_branch tg_4
tgd_5:
    s_lshl_b32 s71, s2, 2
    s_add_u32 s71, s71, 90112
    buffer_store_dword v9, v1, s[4:7], s71 offen sc1
    s_mov_b64 exec, -1
    s_endpgm
A_conv:
    s_sub_u32 s3, s2, 152
    s_load_dwordx8 s[24:31], s[0:1], 8
    s_load_dwordx8 s[32:39], s[0:1], 40
    s_bfe_u32 s101, s3, 0x10003
    s_lshl_b32 s96, s101, 4
    s_add_u32 s96, s96, 80
    s_load_dwordx2 s[12:13], s[0:1], s96
    s_and_b32 s94, s3, 7
    s_lshr_b32 s100, s3, 4
    s_lshr_b32 s95, s3, 5
    s_bfe_u32 s97, s3, 0x20003
    s_lshl_b32 s3, s95, 5
    s_lshl_b32 s96, s94, 2
    s_add_u32 s3, s3, s96
    s_add_u32 s3, s3, s97
    s_and_b32 s97, s100, 1
    s_cmp_lg_u32 s101, 0
    s_cbranch_scc1 A_cw2
    s_mul_i32 s98, s95, 294912
    s_mul_i32 s99, s94, 1152
    s_add_u32 s98, s98, s99
    s_mov_b32 s96, 9216
    s_mov_b32 s99, 7208960
    s_branch A_cwc
A_cw2:
    s_mul_i32 s98, s94, 18
    s_add_u32 s98, s98, s95
    s_mul_i32 s98, s98, 36864
    s_mov_b32 s96, 1152
    s_mov_b32 s99, 12517376
A_cwc:
    s_mul_i32 s100, s97, 576
    s_add_u32 s98, s98, s100
    s_mul_i32 s100, s94, 663552
    s_add_u32 s99, s99, s100
    s_mul_i32 s100, s95, 3072
    s_add_u32 s99, s99, s100
    s_mul_i32 s100, s97, 331776
    s_add_u32 s99, s99, s100
    v_lshrrev_b32 v9, 4, v7
    v_and_b32 v6, 15, v7
    v_and_b32 v1, 127, v0
    v_lshlrev_b32 v1, 1, v1
    s_lshl_b32 s72, s3, 8
    s_lshl_b32 s73, s3, 1
    v_mov_b32 v2, 0
    s_waitcnt lgkmcnt(0)
    s_mov_b32 s64, s36
    s_and_b32 s65, s37, 0xffff
    s_mov_b32 s66, 1152
    s_mov_b32 s67, 0x20000
    buffer_load_ushort v16, v2, s[64:67], s73 offen
    s_mov_b32 s40, s24
    s_and_b32 s41, s25, 0xffff
    s_mov_b32 s42, 147456
    s_mov_b32 s43, 0x20000
    buffer_load_ushort v10, v1, s[40:43], s72 offen
    s_mov_b32 s44, s26
    s_and_b32 s45, s27, 0xffff
    s_mov_b32 s46, 147456
    s_mov_b32 s47, 0x20000
    buffer_load_ushort v11, v1, s[44:47], s72 offen
    s_mov_b32 s48, s28
    s_and_b32 s49, s29, 0xffff
    s_mov_b32 s50, 147456
    s_mov_b32 s51, 0x20000
    buffer_load_ushort v12, v1, s[48:51], s72 offen
    s_mov_b32 s52, s30
    s_and_b32 s53, s31, 0xffff
    s_mov_b32 s54, 147456
    s_mov_b32 s55, 0x20000
    buffer_load_ushort v13, v1, s[52:55], s72 offen
    s_mov_b32 s56, s32
    s_and_b32 s57, s33, 0xffff
    s_mov_b32 s58, 147456
    s_mov_b32 s59, 0x20000
    buffer_load_ushort v14, v1, s[56:59], s72 offen
    s_mov_b32 s60, s34
    s_and_b32 s61, s35, 0xffff
    s_mov_b32 s62, 147456
    s_mov_b32 s63, 0x20000
    buffer_load_ushort v15, v1, s[60:63], s72 offen
    s_mov_b32 s64, s38
    s_and_b32 s65, s39, 0xffff
    s_mov_b32 s66, 1152
    s_mov_b32 s67, 0x20000
    buffer_load_ushort v17, v2, s[64:67], s73 offen
    s_mov_b32 s4, s22
    s_and_b32 s5, s23, 0xffff
    s_mov_b32 s6, 268435456
    s_mov_b32 s7, 0x20000
    s_mov_b32 s16, s20
    s_and_b32 s17, s21, 0xffff
    s_mov_b32 s18, 256
    s_mov_b32 s19, 0x20000
    v_lshrrev_b32 v26, 3, v6
    v_and_b32 v27, 7, v6
    v_lshl_add_u32 v20, v26, 7, v27
    v_bfe_u32 v26, v6, 2, 1
    v_and_b32 v27, 3, v6
    v_lshl_add_u32 v24, v26, 6, v27
    v_add_u32 v24, 128, v24
    v_bfe_u32 v26, v6, 1, 2
    v_and_b32 v27, 1, v6
    v_lshlrev_b32 v27, 1, v27
    v_lshl_add_u32 v28, v26, 6, v27
    v_add_u32 v28, 256, v28
    v_cmp_lt_u32 vcc, 7, v6
    s_nop 1
    v_cndmask_b32 v24, v24, v28, vcc
    v_lshlrev_b32 v21, 1, v24
    v_add_u32 v25, 8, v6
    v_lshlrev_b32 v22, 7, v25
    v_lshlrev_b32 v23, 3, v6
    v_cvt_f32_u32 v20, v20
    v_cvt_f32_u32 v21, v21
    v_cvt_f32_u32 v22, v22
    v_cvt_f32_u32 v23, v23
    v_cvt_f32_u32 v24, v24
    v_cvt_f32_u32 v25, v25
    v_lshlrev_b32 v26, 3, v0
    v_sub_u32 v26, 2047, v26
    v_subrev_u32 v100, 0, v26
    v_subrev_u32 v101, 1, v26
    v_subrev_u32 v102, 2, v26
    v_subrev_u32 v103, 3, v26
    v_subrev_u32 v104, 4, v26
    v_subrev_u32 v105, 5, v26
    v_subrev_u32 v106, 6, v26
    v_subrev_u32 v107, 7, v26
    v_subrev_u32 v108, 8, v26
    v_subrev_u32 v109, 9, v26
    v_subrev_u32 v110, 10, v26
    v_max_i32 v27, 0, v100
    v_cvt_f32_u32 v27, v27
    v_max_i32 v28, 0, v101
    v_cvt_f32_u32 v28, v28
    v_cvt_pk_bf16_f32 v27, v27, v28
    v_lshrrev_b32 v28, 16, v27
    v_and_b32 v27, 0xffff, v27
    v_subrev_u32 v27, 17024, v27
    v_cmp_lt_i32 vcc, 127, v100
    s_nop 1
    v_cndmask_b32 v27, v100, v27, vcc
    v_max_i32 v27, -1, v27
    v_lshlrev_b32 v100, 1, v27
    v_add_u32 v100, 17664, v100
    v_subrev_u32 v28, 17024, v28
    v_cmp_lt_i32 vcc, 127, v101
    s_nop 1
    v_cndmask_b32 v28, v101, v28, vcc
    v_max_i32 v28, -1, v28
    v_lshlrev_b32 v101, 1, v28
    v_add_u32 v101, 17664, v101
    v_max_i32 v27, 0, v102
    v_cvt_f32_u32 v27, v27
    v_max_i32 v28, 0, v103
    v_cvt_f32_u32 v28, v28
    v_cvt_pk_bf16_f32 v27, v27, v28
    v_lshrrev_b32 v28, 16, v27
    v_and_b32 v27, 0xffff, v27
    v_subrev_u32 v27, 17024, v27
    v_cmp_lt_i32 vcc, 127, v102
    s_nop 1
    v_cndmask_b32 v27, v102, v27, vcc
    v_max_i32 v27, -1, v27
    v_lshlrev_b32 v102, 1, v27
    v_add_u32 v102, 17664, v102
    v_subrev_u32 v28, 17024, v28
    v_cmp_lt_i32 vcc, 127, v103
    s_nop 1
    v_cndmask_b32 v28, v103, v28, vcc
    v_max_i32 v28, -1, v28
    v_lshlrev_b32 v103, 1, v28
    v_add_u32 v103, 17664, v103
    v_max_i32 v27, 0, v104
    v_cvt_f32_u32 v27, v27
    v_max_i32 v28, 0, v105
    v_cvt_f32_u32 v28, v28
    v_cvt_pk_bf16_f32 v27, v27, v28
    v_lshrrev_b32 v28, 16, v27
    v_and_b32 v27, 0xffff, v27
    v_subrev_u32 v27, 17024, v27
    v_cmp_lt_i32 vcc, 127, v104
    s_nop 1
    v_cndmask_b32 v27, v104, v27, vcc
    v_max_i32 v27, -1, v27
    v_lshlrev_b32 v104, 1, v27
    v_add_u32 v104, 17664, v104
    v_subrev_u32 v28, 17024, v28
    v_cmp_lt_i32 vcc, 127, v105
    s_nop 1
    v_cndmask_b32 v28, v105, v28, vcc
    v_max_i32 v28, -1, v28
    v_lshlrev_b32 v105, 1, v28
    v_add_u32 v105, 17664, v105
    v_max_i32 v27, 0, v106
    v_cvt_f32_u32 v27, v27
    v_max_i32 v28, 0, v107
    v_cvt_f32_u32 v28, v28
    v_cvt_pk_bf16_f32 v27, v27, v28
    v_lshrrev_b32 v28, 16, v27
    v_and_b32 v27, 0xffff, v27
    v_subrev_u32 v27, 17024, v27
    v_cmp_lt_i32 vcc, 127, v106
    s_nop 1
    v_cndmask_b32 v27, v106, v27, vcc
    v_max_i32 v27, -1, v27
    v_lshlrev_b32 v106, 1, v27
    v_add_u32 v106, 17664, v106
    v_subrev_u32 v28, 17024, v28
    v_cmp_lt_i32 vcc, 127, v107
    s_nop 1
    v_cndmask_b32 v28, v107, v28, vcc
    v_max_i32 v28, -1, v28
    v_lshlrev_b32 v107, 1, v28
    v_add_u32 v107, 17664, v107
    v_max_i32 v27, 0, v108
    v_cvt_f32_u32 v27, v27
    v_max_i32 v28, 0, v109
    v_cvt_f32_u32 v28, v28
    v_cvt_pk_bf16_f32 v27, v27, v28
    v_lshrrev_b32 v28, 16, v27
    v_and_b32 v27, 0xffff, v27
    v_subrev_u32 v27, 17024, v27
    v_cmp_lt_i32 vcc, 127, v108
    s_nop 1
    v_cndmask_b32 v27, v108, v27, vcc
    v_max_i32 v27, -1, v27
    v_lshlrev_b32 v108, 1, v27
    v_add_u32 v108, 17664, v108
    v_subrev_u32 v28, 17024, v28
    v_cmp_lt_i32 vcc, 127, v109
    s_nop 1
    v_cndmask_b32 v28, v109, v28, vcc
    v_max_i32 v28, -1, v28
    v_lshlrev_b32 v109, 1, v28
    v_add_u32 v109, 17664, v109
    v_max_i32 v27, 0, v110
    v_cvt_f32_u32 v27, v27
    v_cvt_pk_bf16_f32 v27, v27, v28
    v_lshrrev_b32 v28, 16, v27
    v_and_b32 v27, 0xffff, v27
    v_subrev_u32 v27, 17024, v27
    v_cmp_lt_i32 vcc, 127, v110
    s_nop 1
    v_cndmask_b32 v27, v110, v27, vcc
    v_max_i32 v27, -1, v27
    v_lshlrev_b32 v110, 1, v27
    v_add_u32 v110, 17664, v110
    s_and_b32 s13, s13, 0xffff
    s_mov_b32 s14, 5308416
    s_mov_b32 s15, 0x20000
    s_mov_b32 s95, 119304648
    s_add_u32 s97, s75, 0
    s_min_u32 s97, s97, 17
    s_lshl_b32 s97, s97, 6
    v_add_u32 v27, s97, v7
    v_mul_hi_u32 v28, v27, s95
    v_mul_u32_u24 v29, 36, v28
    v_sub_u32 v27, v27, v29
    v_mul_lo_u32 v28, v28, s96
    v_lshl_add_u32 v120, v27, 4, v28
    s_add_u32 s97, s75, 4
    s_min_u32 s97, s97, 17
    s_lshl_b32 s97, s97, 6
    v_add_u32 v27, s97, v7
    v_mul_hi_u32 v28, v27, s95
    v_mul_u32_u24 v29, 36, v28
    v_sub_u32 v27, v27, v29
    v_mul_lo_u32 v28, v28, s96
    v_lshl_add_u32 v121, v27, 4, v28
    s_add_u32 s97, s75, 8
    s_min_u32 s97, s97, 17
    s_lshl_b32 s97, s97, 6
    v_add_u32 v27, s97, v7
    v_mul_hi_u32 v28, v27, s95
    v_mul_u32_u24 v29, 36, v28
    v_sub_u32 v27, v27, v29
    v_mul_lo_u32 v28, v28, s96
    v_lshl_add_u32 v122, v27, 4, v28
    s_add_u32 s97, s75, 12
    s_min_u32 s97, s97, 17
    s_lshl_b32 s97, s97, 6
    v_add_u32 v27, s97, v7
    v_mul_hi_u32 v28, v27, s95
    v_mul_u32_u24 v29, 36, v28
    v_sub_u32 v27, v27, v29
    v_mul_lo_u32 v28, v28, s96
    v_lshl_add_u32 v123, v27, 4, v28
    s_add_u32 s97, s75, 16
    s_min_u32 s97, s97, 17
    s_lshl_b32 s97, s97, 6
    v_add_u32 v27, s97, v7
    v_mul_hi_u32 v28, v27, s95
    v_mul_u32_u24 v29, 36, v28
    v_sub_u32 v27, v27, v29
    v_mul_lo_u32 v28, v28, s96
    v_lshl_add_u32 v124, v27, 4, v28
    s_waitcnt vmcnt(0)
    s_add_u32 s97, s75, 0
    s_min_u32 s97, s97, 17
    s_lshl_b32 s97, s97, 10
    s_add_u32 m0, s97, 21248
    s_nop 0
    buffer_load_dwordx4 v120, s[12:15], s98 offen  lds
    s_add_u32 s97, s75, 4
    s_min_u32 s97, s97, 17
    s_lshl_b32 s97, s97, 10
    s_add_u32 m0, s97, 21248
    s_nop 0
    buffer_load_dwordx4 v121, s[12:15], s98 offen  lds
    s_add_u32 s97, s75, 8
    s_min_u32 s97, s97, 17
    s_lshl_b32 s97, s97, 10
    s_add_u32 m0, s97, 21248
    s_nop 0
    buffer_load_dwordx4 v122, s[12:15], s98 offen  lds
    s_add_u32 s97, s75, 12
    s_min_u32 s97, s97, 17
    s_lshl_b32 s97, s97, 10
    s_add_u32 m0, s97, 21248
    s_nop 0
    buffer_load_dwordx4 v123, s[12:15], s98 offen  lds
    s_add_u32 s97, s75, 16
    s_min_u32 s97, s97, 17
    s_lshl_b32 s97, s97, 10
    s_add_u32 m0, s97, 21248
    s_nop 0
    buffer_load_dwordx4 v124, s[12:15], s98 offen  lds
    v_lshlrev_b32 v10, 16, v10
    v_lshlrev_b32 v11, 16, v11
    v_lshlrev_b32 v12, 16, v12
    v_lshlrev_b32 v13, 16, v13
    v_lshlrev_b32 v14, 16, v14
    v_lshlrev_b32 v15, 16, v15
    v_lshlrev_b32 v16, 16, v16
    v_lshlrev_b32 v17, 16, v17
    s_nop 0
    v_readfirstlane_b32 s74, v17
    v_mul_f32 v16, 0x3fb8aa3b, v16
    v_exp_f32 v16, v16
    s_nop 0
    v_cvt_pk_bf16_f32 v16, v16, v16
    v_and_b32 v16, 0xffff0000, v16
    v_mul_f32 v28, v16, v10
    v_mul_f32 v28, 0x3fb8aa3b, v28
    v_mul_f32 v29, v16, v11
    v_mul_f32 v29, 0x3e22f983, v29
    v_rndne_f32 v30, v29
    v_sub_f32 v29, v29, v30
    v_add_f32 v30, v29, v29
    v_rndne_f32 v31, v30
    v_sub_f32 v30, v30, v31
    v_mul_f32 v31, 0x43000000, v29
    v_rndne_f32 v32, v31
    v_sub_f32 v31, v31, v32
    v_mul_f32 v12, v16, v12
    v_mul_f32 v13, v16, v13
    v_mul_f32 v32, v14, v12
    v_fma_f32 v32, -v15, v13, v32
    v_mul_f32 v33, v14, v13
    v_fma_f32 v33, v15, v12, v33
    v_lshlrev_b32 v1, 4, v1
    ds_write_b128 v1, v[28:31] offset:0
    ds_write_b64 v1, v[32:33] offset:16
    v_lshl_add_u32 v3, v8, 5, v9
    v_lshlrev_b32 v3, 5, v3
    s_waitcnt lgkmcnt(0)
    s_barrier
    ds_read_b128 v[52:55], v3 offset:0
    ds_read_b64 v[56:57], v3 offset:16
    ds_read_b128 v[58:61], v3 offset:128
    ds_read_b64 v[62:63], v3 offset:144
    ds_read_b128 v[64:67], v3 offset:256
    ds_read_b64 v[68:69], v3 offset:272
    ds_read_b128 v[70:73], v3 offset:384
    ds_read_b64 v[74:75], v3 offset:400
    ds_read_b128 v[76:79], v3 offset:512
    ds_read_b64 v[80:81], v3 offset:528
    ds_read_b128 v[82:85], v3 offset:640
    ds_read_b64 v[86:87], v3 offset:656
    ds_read_b128 v[88:91], v3 offset:768
    ds_read_b64 v[92:93], v3 offset:784
    ds_read_b128 v[94:97], v3 offset:896
    ds_read_b64 v[98:99], v3 offset:912
    s_waitcnt lgkmcnt(14)
    v_mul_f32 v10, v52, v20
    v_mul_f32 v11, v52, v21
    v_mul_f32 v12, v52, v22
    v_mul_f32 v13, v52, v23
    v_mul_f32 v14, v53, v20
    v_mul_f32 v15, v54, v24
    v_mul_f32 v16, v55, v25
    v_mul_f32 v17, v53, v23
    v_exp_f32 v13, v13
    v_exp_f32 v10, v10
    v_exp_f32 v11, v11
    v_exp_f32 v12, v12
    v_cos_f32 v119, v17
    v_sin_f32 v17, v17
    v_cos_f32 v116, v14
    v_sin_f32 v14, v14
    v_cos_f32 v117, v15
    v_sin_f32 v15, v15
    v_cos_f32 v118, v16
    v_sin_f32 v16, v16
    v_mul_f32 v18, v56, v13
    v_mul_f32 v19, v57, v13
    v_mul_f32 v26, v18, v119
    v_mul_f32 v27, v18, v17
    v_fma_f32 v26, -v19, v17, v26
    v_fma_f32 v27, -v19, v119, -v27
    v_mul_f32 v116, v10, v116
    v_mul_f32 v14, v10, v14
    v_mul_f32 v117, v11, v117
    v_mul_f32 v15, v11, v15
    v_mul_f32 v118, v12, v118
    v_mul_f32 v16, v12, v16
    v_cvt_pk_bf16_f32 v112, v26, v27
    v_cvt_pk_bf16_f32 v28, v116, v14
    v_cvt_pk_bf16_f32 v32, v117, v15
    v_cvt_pk_bf16_f32 v36, v118, v16
    s_waitcnt lgkmcnt(12)
    v_mul_f32 v10, v58, v20
    v_mul_f32 v11, v58, v21
    v_mul_f32 v12, v58, v22
    v_mul_f32 v13, v58, v23
    v_mul_f32 v14, v59, v20
    v_mul_f32 v15, v60, v24
    v_mul_f32 v16, v61, v25
    v_mul_f32 v17, v59, v23
    v_exp_f32 v13, v13
    v_exp_f32 v10, v10
    v_exp_f32 v11, v11
    v_exp_f32 v12, v12
    v_cos_f32 v119, v17
    v_sin_f32 v17, v17
    v_cos_f32 v116, v14
    v_sin_f32 v14, v14
    v_cos_f32 v117, v15
    v_sin_f32 v15, v15
    v_cos_f32 v118, v16
    v_sin_f32 v16, v16
    v_mul_f32 v18, v62, v13
    v_mul_f32 v19, v63, v13
    v_mul_f32 v26, v18, v119
    v_mul_f32 v27, v18, v17
    v_fma_f32 v26, -v19, v17, v26
    v_fma_f32 v27, -v19, v119, -v27
    v_mul_f32 v116, v10, v116
    v_mul_f32 v14, v10, v14
    v_mul_f32 v117, v11, v117
    v_mul_f32 v15, v11, v15
    v_mul_f32 v118, v12, v118
    v_mul_f32 v16, v12, v16
    v_cvt_pk_bf16_f32 v113, v26, v27
    v_cvt_pk_bf16_f32 v29, v116, v14
    v_cvt_pk_bf16_f32 v33, v117, v15
    v_cvt_pk_bf16_f32 v37, v118, v16
    s_waitcnt lgkmcnt(10)
    v_mul_f32 v10, v64, v20
    v_mul_f32 v11, v64, v21
    v_mul_f32 v12, v64, v22
    v_mul_f32 v13, v64, v23
    v_mul_f32 v14, v65, v20
    v_mul_f32 v15, v66, v24
    v_mul_f32 v16, v67, v25
    v_mul_f32 v17, v65, v23
    v_exp_f32 v13, v13
    v_exp_f32 v10, v10
    v_exp_f32 v11, v11
    v_exp_f32 v12, v12
    v_cos_f32 v119, v17
    v_sin_f32 v17, v17
    v_cos_f32 v116, v14
    v_sin_f32 v14, v14
    v_cos_f32 v117, v15
    v_sin_f32 v15, v15
    v_cos_f32 v118, v16
    v_sin_f32 v16, v16
    v_mul_f32 v18, v68, v13
    v_mul_f32 v19, v69, v13
    v_mul_f32 v26, v18, v119
    v_mul_f32 v27, v18, v17
    v_fma_f32 v26, -v19, v17, v26
    v_fma_f32 v27, -v19, v119, -v27
    v_mul_f32 v116, v10, v116
    v_mul_f32 v14, v10, v14
    v_mul_f32 v117, v11, v117
    v_mul_f32 v15, v11, v15
    v_mul_f32 v118, v12, v118
    v_mul_f32 v16, v12, v16
    v_cvt_pk_bf16_f32 v114, v26, v27
    v_cvt_pk_bf16_f32 v30, v116, v14
    v_cvt_pk_bf16_f32 v34, v117, v15
    v_cvt_pk_bf16_f32 v38, v118, v16
    s_waitcnt lgkmcnt(8)
    v_mul_f32 v10, v70, v20
    v_mul_f32 v11, v70, v21
    v_mul_f32 v12, v70, v22
    v_mul_f32 v13, v70, v23
    v_mul_f32 v14, v71, v20
    v_mul_f32 v15, v72, v24
    v_mul_f32 v16, v73, v25
    v_mul_f32 v17, v71, v23
    v_exp_f32 v13, v13
    v_exp_f32 v10, v10
    v_exp_f32 v11, v11
    v_exp_f32 v12, v12
    v_cos_f32 v119, v17
    v_sin_f32 v17, v17
    v_cos_f32 v116, v14
    v_sin_f32 v14, v14
    v_cos_f32 v117, v15
    v_sin_f32 v15, v15
    v_cos_f32 v118, v16
    v_sin_f32 v16, v16
    v_mul_f32 v18, v74, v13
    v_mul_f32 v19, v75, v13
    v_mul_f32 v26, v18, v119
    v_mul_f32 v27, v18, v17
    v_fma_f32 v26, -v19, v17, v26
    v_fma_f32 v27, -v19, v119, -v27
    v_mul_f32 v116, v10, v116
    v_mul_f32 v14, v10, v14
    v_mul_f32 v117, v11, v117
    v_mul_f32 v15, v11, v15
    v_mul_f32 v118, v12, v118
    v_mul_f32 v16, v12, v16
    v_cvt_pk_bf16_f32 v115, v26, v27
    v_cvt_pk_bf16_f32 v31, v116, v14
    v_cvt_pk_bf16_f32 v35, v117, v15
    v_cvt_pk_bf16_f32 v39, v118, v16
    v_mfma_f32_16x16x32_bf16 v[40:43], v[28:31], v[112:115], 0
    v_mfma_f32_16x16x32_bf16 v[44:47], v[32:35], v[112:115], 0
    v_mfma_f32_16x16x32_bf16 v[48:51], v[36:39], v[112:115], 0
    s_waitcnt lgkmcnt(6)
    v_mul_f32 v10, v76, v20
    v_mul_f32 v11, v76, v21
    v_mul_f32 v12, v76, v22
    v_mul_f32 v13, v76, v23
    v_mul_f32 v14, v77, v20
    v_mul_f32 v15, v78, v24
    v_mul_f32 v16, v79, v25
    v_mul_f32 v17, v77, v23
    v_exp_f32 v13, v13
    v_exp_f32 v10, v10
    v_exp_f32 v11, v11
    v_exp_f32 v12, v12
    v_cos_f32 v119, v17
    v_sin_f32 v17, v17
    v_cos_f32 v116, v14
    v_sin_f32 v14, v14
    v_cos_f32 v117, v15
    v_sin_f32 v15, v15
    v_cos_f32 v118, v16
    v_sin_f32 v16, v16
    v_mul_f32 v18, v80, v13
    v_mul_f32 v19, v81, v13
    v_mul_f32 v26, v18, v119
    v_mul_f32 v27, v18, v17
    v_fma_f32 v26, -v19, v17, v26
    v_fma_f32 v27, -v19, v119, -v27
    v_mul_f32 v116, v10, v116
    v_mul_f32 v14, v10, v14
    v_mul_f32 v117, v11, v117
    v_mul_f32 v15, v11, v15
    v_mul_f32 v118, v12, v118
    v_mul_f32 v16, v12, v16
    v_cvt_pk_bf16_f32 v112, v26, v27
    v_cvt_pk_bf16_f32 v28, v116, v14
    v_cvt_pk_bf16_f32 v32, v117, v15
    v_cvt_pk_bf16_f32 v36, v118, v16
    s_waitcnt lgkmcnt(4)
    v_mul_f32 v10, v82, v20
    v_mul_f32 v11, v82, v21
    v_mul_f32 v12, v82, v22
    v_mul_f32 v13, v82, v23
    v_mul_f32 v14, v83, v20
    v_mul_f32 v15, v84, v24
    v_mul_f32 v16, v85, v25
    v_mul_f32 v17, v83, v23
    v_exp_f32 v13, v13
    v_exp_f32 v10, v10
    v_exp_f32 v11, v11
    v_exp_f32 v12, v12
    v_cos_f32 v119, v17
    v_sin_f32 v17, v17
    v_cos_f32 v116, v14
    v_sin_f32 v14, v14
    v_cos_f32 v117, v15
    v_sin_f32 v15, v15
    v_cos_f32 v118, v16
    v_sin_f32 v16, v16
    v_mul_f32 v18, v86, v13
    v_mul_f32 v19, v87, v13
    v_mul_f32 v26, v18, v119
    v_mul_f32 v27, v18, v17
    v_fma_f32 v26, -v19, v17, v26
    v_fma_f32 v27, -v19, v119, -v27
    v_mul_f32 v116, v10, v116
    v_mul_f32 v14, v10, v14
    v_mul_f32 v117, v11, v117
    v_mul_f32 v15, v11, v15
    v_mul_f32 v118, v12, v118
    v_mul_f32 v16, v12, v16
    v_cvt_pk_bf16_f32 v113, v26, v27
    v_cvt_pk_bf16_f32 v29, v116, v14
    v_cvt_pk_bf16_f32 v33, v117, v15
    v_cvt_pk_bf16_f32 v37, v118, v16
    s_waitcnt lgkmcnt(2)
    v_mul_f32 v10, v88, v20
    v_mul_f32 v11, v88, v21
    v_mul_f32 v12, v88, v22
    v_mul_f32 v13, v88, v23
    v_mul_f32 v14, v89, v20
    v_mul_f32 v15, v90, v24
    v_mul_f32 v16, v91, v25
    v_mul_f32 v17, v89, v23
    v_exp_f32 v13, v13
    v_exp_f32 v10, v10
    v_exp_f32 v11, v11
    v_exp_f32 v12, v12
    v_cos_f32 v119, v17
    v_sin_f32 v17, v17
    v_cos_f32 v116, v14
    v_sin_f32 v14, v14
    v_cos_f32 v117, v15
    v_sin_f32 v15, v15
    v_cos_f32 v118, v16
    v_sin_f32 v16, v16
    v_mul_f32 v18, v92, v13
    v_mul_f32 v19, v93, v13
    v_mul_f32 v26, v18, v119
    v_mul_f32 v27, v18, v17
    v_fma_f32 v26, -v19, v17, v26
    v_fma_f32 v27, -v19, v119, -v27
    v_mul_f32 v116, v10, v116
    v_mul_f32 v14, v10, v14
    v_mul_f32 v117, v11, v117
    v_mul_f32 v15, v11, v15
    v_mul_f32 v118, v12, v118
    v_mul_f32 v16, v12, v16
    v_cvt_pk_bf16_f32 v114, v26, v27
    v_cvt_pk_bf16_f32 v30, v116, v14
    v_cvt_pk_bf16_f32 v34, v117, v15
    v_cvt_pk_bf16_f32 v38, v118, v16
    s_waitcnt lgkmcnt(0)
    v_mul_f32 v10, v94, v20
    v_mul_f32 v11, v94, v21
    v_mul_f32 v12, v94, v22
    v_mul_f32 v13, v94, v23
    v_mul_f32 v14, v95, v20
    v_mul_f32 v15, v96, v24
    v_mul_f32 v16, v97, v25
    v_mul_f32 v17, v95, v23
    v_exp_f32 v13, v13
    v_exp_f32 v10, v10
    v_exp_f32 v11, v11
    v_exp_f32 v12, v12
    v_cos_f32 v119, v17
    v_sin_f32 v17, v17
    v_cos_f32 v116, v14
    v_sin_f32 v14, v14
    v_cos_f32 v117, v15
    v_sin_f32 v15, v15
    v_cos_f32 v118, v16
    v_sin_f32 v16, v16
    v_mul_f32 v18, v98, v13
    v_mul_f32 v19, v99, v13
    v_mul_f32 v26, v18, v119
    v_mul_f32 v27, v18, v17
    v_fma_f32 v26, -v19, v17, v26
    v_fma_f32 v27, -v19, v119, -v27
    v_mul_f32 v116, v10, v116
    v_mul_f32 v14, v10, v14
    v_mul_f32 v117, v11, v117
    v_mul_f32 v15, v11, v15
    v_mul_f32 v118, v12, v118
    v_mul_f32 v16, v12, v16
    v_cvt_pk_bf16_f32 v115, v26, v27
    v_cvt_pk_bf16_f32 v31, v116, v14
    v_cvt_pk_bf16_f32 v35, v117, v15
    v_cvt_pk_bf16_f32 v39, v118, v16
    v_mfma_f32_16x16x32_bf16 v[40:43], v[28:31], v[112:115], v[40:43]
    v_mfma_f32_16x16x32_bf16 v[44:47], v[32:35], v[112:115], v[44:47]
    v_mfma_f32_16x16x32_bf16 v[48:51], v[36:39], v[112:115], v[48:51]
    v_mul_u32_u24 v24, 3072, v8
    v_add_u32 v24, 4096, v24
    v_lshrrev_b32 v25, 1, v9
    v_and_b32 v26, 1, v9
    v_lshlrev_b32 v27, 9, v25
    v_lshl_add_u32 v27, v6, 5, v27
    v_lshl_add_u32 v27, v26, 4, v27
    v_add_u32 v27, v24, v27
    v_lshlrev_b32 v18, 8, v26
    v_lshl_add_u32 v19, v6, 4, v18
    v_add_u32 v19, 1024, v19
    v_add_u32 v10, 8, v19
    v_lshl_add_u32 v11, v6, 3, v18
    v_add_u32 v11, 1536, v11
    v_add_u32 v12, 128, v11
    v_cmp_lt_u32 vcc, 1, v9
    s_nop 1
    v_cndmask_b32 v19, v19, v11, vcc
    v_cndmask_b32 v10, v10, v12, vcc
    v_add_u32 v19, v24, v19
    v_add_u32 v10, v24, v10
    v_lshlrev_b32 v11, 8, v9
    v_lshl_add_u32 v11, v6, 2, v11
    v_add_u32 v11, v24, v11
    ds_write_b128 v27, v[40:43]
    ds_write_b64 v19, v[44:45]
    ds_write_b64 v10, v[46:47]
    ds_write_b32 v11, v48 offset:2048
    ds_write_b32 v11, v49 offset:2112
    ds_write_b32 v11, v50 offset:2176
    ds_write_b32 v11, v51 offset:2240
    v_mov_b32 v12, 0
    v_mov_b32 v13, 0
    v_lshlrev_b32 v14, 2, v0
    ds_write_b32 v14, v12 offset:16640
    s_waitcnt lgkmcnt(0)
    s_barrier
    v_min_u32 v24, 191, v0
    v_lshlrev_b32 v25, 4, v24
    ds_read_b128 v[40:43], v25 offset:4096
    ds_read_b128 v[44:47], v25 offset:7168
    ds_read_b128 v[48:51], v25 offset:10240
    ds_read_b128 v[52:55], v25 offset:13312
    s_waitcnt lgkmcnt(0)
    v_pk_add_f32 v[40:41], v[40:41], v[44:45]
    v_pk_add_f32 v[48:49], v[48:49], v[52:53]
    s_nop 0
    v_pk_add_f32 v[40:41], v[40:41], v[48:49]
    v_pk_add_f32 v[42:43], v[42:43], v[46:47]
    v_pk_add_f32 v[50:51], v[50:51], v[54:55]
    s_nop 0
    v_pk_add_f32 v[42:43], v[42:43], v[50:51]
    v_cvt_pk_bf16_f32 v40, v40, v41
    v_cvt_pk_bf16_f32 v41, v42, v43
    v_lshlrev_b32 v25, 3, v24
    ds_write_b64 v25, v[40:41] offset:17664
    s_waitcnt lgkmcnt(0)
    s_barrier
    ds_read_u16 v60, v100
    ds_read_u16 v61, v101
    ds_read_u16 v62, v102
    ds_read_u16 v63, v103
    ds_read_u16 v64, v104
    ds_read_u16 v65, v105
    ds_read_u16 v66, v106
    ds_read_u16 v67, v107
    ds_read_u16 v68, v108
    ds_read_u16 v69, v109
    ds_read_u16 v70, v110
    v_lshlrev_b32 v25, 4, v0
    v_lshlrev_b32 v15, 2, v7
    v_mul_u32_u24 v16, 4160, v8
    v_min_u32 v15, 60, v15
    v_add_u32 v15, v15, v16
    ds_write_b32 v15, v12 offset:4096
    s_waitcnt lgkmcnt(0)
    v_lshl_or_b32 v40, v61, 16, v60
    v_lshl_or_b32 v41, v63, 16, v62
    v_lshl_or_b32 v42, v65, 16, v64
    v_lshl_or_b32 v43, v67, 16, v66
    ds_write_b128 v25, v[40:43] offset:0
    v_lshl_or_b32 v44, v62, 16, v61
    v_lshl_or_b32 v45, v64, 16, v63
    v_lshl_or_b32 v46, v66, 16, v65
    v_lshl_or_b32 v47, v68, 16, v67
    ds_write_b128 v25, v[44:47] offset:4160
    v_lshl_or_b32 v48, v63, 16, v62
    v_lshl_or_b32 v49, v65, 16, v64
    v_lshl_or_b32 v50, v67, 16, v66
    v_lshl_or_b32 v51, v69, 16, v68
    ds_write_b128 v25, v[48:51] offset:8320
    v_lshl_or_b32 v52, v64, 16, v63
    v_lshl_or_b32 v53, v66, 16, v65
    v_lshl_or_b32 v54, v68, 16, v67
    v_lshl_or_b32 v55, v70, 16, v69
    ds_write_b128 v25, v[52:55] offset:12480
    s_waitcnt lgkmcnt(0)
    v_mov_b32 v2, 0
    s_cmp_lg_u32 s75, 0
    s_cbranch_scc1 go_6
    s_mov_b32 s70, 1048576
poll_7:
    buffer_load_dword v10, v2, s[16:19], 0 offen offset:128 sc1
    s_waitcnt vmcnt(0)
    v_readfirstlane_b32 s71, v10
    s_nop 0
    s_cmp_lt_u32 s71, 1
    s_cbranch_scc1 slp_8
    s_branch go_6
slp_8:
    s_sub_u32 s70, s70, 1
    s_cmp_eq_u32 s70, 0
    s_cbranch_scc1 go_6
    s_sleep 4
    s_branch poll_7
go_6:
    s_barrier
    v_lshlrev_b32 v1, 4, v0
    v_lshrrev_b32 v3, 2, v0
    v_mul_u32_u24 v3, 36864, v3
    v_and_b32 v35, 3, v0
    v_lshl_add_u32 v3, v35, 4, v3
    s_lshl_b32 s26, s3, 6
    s_add_u32 s26, s26, 131072
    buffer_load_dwordx4 v[10:13], v3, s[4:7], s26 offen sc1
    v_lshlrev_b32 v3, 5, v0
    s_mov_b32 s27, 32768
    buffer_load_dwordx4 v[16:19], v3, s[4:7], s27 offen sc1
    buffer_load_dwordx4 v[20:23], v3, s[4:7], s27 offen offset:16 sc1
    v_lshrrev_b32 v15, 1, v7
    v_min_u32 v15, 2, v15
    v_and_b32 v14, 1, v7
    v_mul_u32_u24 v14, 13824, v14
    v_mul_u32_u24 v34, 2304, v15
    v_add_u32 v14, v14, v34
    s_lshl_b32 s29, s3, 2
    s_add_u32 s30, s29, 49152
    buffer_load_dword v32, v14, s[4:7], s30 offen sc1
    v_sub_u32 v4, 3, v6
    v_and_b32 v4, 3, v4
    v_lshlrev_b32 v5, 3, v9
    v_sub_u32 v5, v5, v6
    v_add_u32 v5, 15, v5
    v_sub_u32 v5, v5, v4
    v_lshlrev_b32 v5, 1, v5
    v_mul_u32_u24 v4, 4160, v4
    v_add_u32 v4, v4, v5
    v_sub_u32 v5, 3, v8
    v_lshlrev_b32 v5, 7, v5
    v_add_u32 v4, v4, v5
    v_lshlrev_b32 v33, 5, v6
    v_lshl_add_u32 v33, v9, 4, v33
    v_add_u32 v5, v5, v33
    v_add_u32 v5, 16672, v5
    ds_read_b64 v[100:101], v4 offset:3648
    ds_read_b64 v[102:103], v4 offset:3656
    ds_read_b64 v[104:105], v4 offset:3136
    ds_read_b64 v[106:107], v4 offset:3144
    ds_read_b64 v[108:109], v4 offset:2624
    ds_read_b64 v[110:111], v4 offset:2632
    ds_read_b64 v[112:113], v4 offset:2112
    ds_read_b64 v[114:115], v4 offset:2120
    ds_read_b64 v[116:117], v4 offset:1600
    ds_read_b64 v[118:119], v4 offset:1608
    ds_read_b64 v[120:121], v4 offset:1088
    ds_read_b64 v[122:123], v4 offset:1096
    ds_read_b64 v[124:125], v4 offset:576
    ds_read_b64 v[126:127], v4 offset:584
    s_waitcnt vmcnt(0)
    v_add_f32_dpp v32, v32, v32 quad_perm:[1,0,3,2] row_mask:0xf bank_mask:0xf
    v_cvt_pk_bf16_f32 v32, v32, v32
    v_and_b32 v32, 0xffff0000, v32
    v_add_f32 v33, 1.0, v32
    v_cvt_pk_bf16_f32 v33, v33, v33
    v_and_b32 v33, 0xffff0000, v33
    v_cmp_eq_u32 vcc, 1, v15
    v_cmp_eq_u32 s[68:69], 4, v15
    s_nop 0
    s_or_b64 vcc, vcc, s[68:69]
    v_cndmask_b32 v32, v32, v33, vcc
    s_add_u32 s30, s29, 0
    v_readlane_b32 s68, v32, 0
    v_readlane_b32 s69, v32, 2
    v_readlane_b32 s73, v32, 4
    v_mov_b32 v34, s68
    v_mov_b32 v14, s69
    v_lshlrev_b32 v36, 16, v10
    v_and_b32 v37, 0xffff0000, v10
    v_lshlrev_b32 v38, 16, v11
    v_and_b32 v39, 0xffff0000, v11
    v_lshlrev_b32 v40, 16, v12
    v_and_b32 v41, 0xffff0000, v12
    v_lshlrev_b32 v42, 16, v13
    v_and_b32 v43, 0xffff0000, v13
    v_lshlrev_b32 v24, 16, v16
    v_lshlrev_b32 v25, 16, v17
    v_lshlrev_b32 v26, 16, v18
    v_lshlrev_b32 v27, 16, v19
    v_lshlrev_b32 v28, 16, v20
    v_lshlrev_b32 v29, 16, v21
    v_lshlrev_b32 v30, 16, v22
    v_lshlrev_b32 v31, 16, v23
    v_and_b32 v16, 0xffff0000, v16
    v_and_b32 v17, 0xffff0000, v17
    v_and_b32 v18, 0xffff0000, v18
    v_and_b32 v19, 0xffff0000, v19
    v_and_b32 v20, 0xffff0000, v20
    v_and_b32 v21, 0xffff0000, v21
    v_and_b32 v22, 0xffff0000, v22
    v_and_b32 v23, 0xffff0000, v23
    v_rcp_f32 v24, v24
    v_rcp_f32 v25, v25
    v_rcp_f32 v26, v26
    v_rcp_f32 v27, v27
    v_rcp_f32 v28, v28
    v_rcp_f32 v29, v29
    v_rcp_f32 v30, v30
    v_rcp_f32 v31, v31
    v_pk_add_f32 v[36:37], v[36:37], v[16:17] neg_lo:[0,1] neg_hi:[0,1]
    v_pk_add_f32 v[38:39], v[38:39], v[18:19] neg_lo:[0,1] neg_hi:[0,1]
    v_pk_add_f32 v[40:41], v[40:41], v[20:21] neg_lo:[0,1] neg_hi:[0,1]
    v_pk_add_f32 v[42:43], v[42:43], v[22:23] neg_lo:[0,1] neg_hi:[0,1]
    v_pk_mul_f32 v[36:37], v[36:37], v[24:25]
    v_pk_mul_f32 v[38:39], v[38:39], v[26:27]
    v_pk_mul_f32 v[40:41], v[40:41], v[28:29]
    v_pk_mul_f32 v[42:43], v[42:43], v[30:31]
    v_pk_fma_f32 v[36:37], v[36:37], v[14:15], v[34:35] op_sel_hi:[1,0,0]
    v_pk_fma_f32 v[38:39], v[38:39], v[14:15], v[34:35] op_sel_hi:[1,0,0]
    v_pk_fma_f32 v[40:41], v[40:41], v[14:15], v[34:35] op_sel_hi:[1,0,0]
    v_pk_fma_f32 v[42:43], v[42:43], v[14:15], v[34:35] op_sel_hi:[1,0,0]
    v_cvt_pk_bf16_f32 v24, v36, v37
    v_cvt_pk_bf16_f32 v25, v38, v39
    v_cvt_pk_bf16_f32 v26, v40, v41
    v_cvt_pk_bf16_f32 v27, v42, v43
    ds_write_b128 v1, v[24:27] offset:17152
    ds_read_b64 v[16:17], v4 offset:64
    ds_read_b64 v[18:19], v4 offset:72
    s_waitcnt lgkmcnt(0)
    s_barrier
    ds_read_b128 v[96:99], v5 offset:3648
    ds_read_b128 v[92:95], v5 offset:3136
    ds_read_b128 v[88:91], v5 offset:2624
    ds_read_b128 v[84:87], v5 offset:2112
    ds_read_b128 v[80:83], v5 offset:1600
    ds_read_b128 v[76:79], v5 offset:1088
    ds_read_b128 v[72:75], v5 offset:576
    ds_read_b128 v[68:71], v5 offset:64
    s_waitcnt lgkmcnt(7)
    v_mfma_f32_16x16x32_bf16 v[64:67], v[100:103], v[96:99], 0
    s_waitcnt lgkmcnt(6)
    v_mfma_f32_16x16x32_bf16 v[60:63], v[100:103], v[92:95], 0
    s_waitcnt lgkmcnt(5)
    v_mfma_f32_16x16x32_bf16 v[56:59], v[100:103], v[88:91], 0
    s_waitcnt lgkmcnt(4)
    v_mfma_f32_16x16x32_bf16 v[52:55], v[100:103], v[84:87], 0
    s_waitcnt lgkmcnt(3)
    v_mfma_f32_16x16x32_bf16 v[48:51], v[100:103], v[80:83], 0
    s_waitcnt lgkmcnt(2)
    v_mfma_f32_16x16x32_bf16 v[44:47], v[100:103], v[76:79], 0
    s_waitcnt lgkmcnt(1)
    v_mfma_f32_16x16x32_bf16 v[40:43], v[100:103], v[72:75], 0
    s_waitcnt lgkmcnt(0)
    v_mfma_f32_16x16x32_bf16 v[36:39], v[100:103], v[68:71], 0
    ds_read_b64 v[100:101], v4 offset:3584
    ds_read_b64 v[102:103], v4 offset:3592
    ds_read_b128 v[96:99], v5 offset:3584
    v_mfma_f32_16x16x32_bf16 v[64:67], v[104:107], v[92:95], v[64:67]
    v_mfma_f32_16x16x32_bf16 v[60:63], v[104:107], v[88:91], v[60:63]
    v_mfma_f32_16x16x32_bf16 v[56:59], v[104:107], v[84:87], v[56:59]
    v_mfma_f32_16x16x32_bf16 v[52:55], v[104:107], v[80:83], v[52:55]
    v_mfma_f32_16x16x32_bf16 v[48:51], v[104:107], v[76:79], v[48:51]
    v_mfma_f32_16x16x32_bf16 v[44:47], v[104:107], v[72:75], v[44:47]
    v_mfma_f32_16x16x32_bf16 v[40:43], v[104:107], v[68:71], v[40:43]
    ds_read_b64 v[104:105], v4 offset:3072
    ds_read_b64 v[106:107], v4 offset:3080
    ds_read_b128 v[92:95], v5 offset:3072
    v_mfma_f32_16x16x32_bf16 v[64:67], v[108:111], v[88:91], v[64:67]
    v_mfma_f32_16x16x32_bf16 v[60:63], v[108:111], v[84:87], v[60:63]
    v_mfma_f32_16x16x32_bf16 v[56:59], v[108:111], v[80:83], v[56:59]
    v_mfma_f32_16x16x32_bf16 v[52:55], v[108:111], v[76:79], v[52:55]
    v_mfma_f32_16x16x32_bf16 v[48:51], v[108:111], v[72:75], v[48:51]
    v_mfma_f32_16x16x32_bf16 v[44:47], v[108:111], v[68:71], v[44:47]
    ds_read_b64 v[108:109], v4 offset:2560
    ds_read_b64 v[110:111], v4 offset:2568
    ds_read_b128 v[88:91], v5 offset:2560
    v_mfma_f32_16x16x32_bf16 v[64:67], v[112:115], v[84:87], v[64:67]
    v_mfma_f32_16x16x32_bf16 v[60:63], v[112:115], v[80:83], v[60:63]
    v_mfma_f32_16x16x32_bf16 v[56:59], v[112:115], v[76:79], v[56:59]
    v_mfma_f32_16x16x32_bf16 v[52:55], v[112:115], v[72:75], v[52:55]
    v_mfma_f32_16x16x32_bf16 v[48:51], v[112:115], v[68:71], v[48:51]
    ds_read_b64 v[112:113], v4 offset:2048
    ds_read_b64 v[114:115], v4 offset:2056
    ds_read_b128 v[84:87], v5 offset:2048
    v_mfma_f32_16x16x32_bf16 v[64:67], v[116:119], v[80:83], v[64:67]
    v_mfma_f32_16x16x32_bf16 v[60:63], v[116:119], v[76:79], v[60:63]
    v_mfma_f32_16x16x32_bf16 v[56:59], v[116:119], v[72:75], v[56:59]
    v_mfma_f32_16x16x32_bf16 v[52:55], v[116:119], v[68:71], v[52:55]
    ds_read_b64 v[116:117], v4 offset:1536
    ds_read_b64 v[118:119], v4 offset:1544
    ds_read_b128 v[80:83], v5 offset:1536
    v_mfma_f32_16x16x32_bf16 v[64:67], v[120:123], v[76:79], v[64:67]
    v_mfma_f32_16x16x32_bf16 v[60:63], v[120:123], v[72:75], v[60:63]
    v_mfma_f32_16x16x32_bf16 v[56:59], v[120:123], v[68:71], v[56:59]
    ds_read_b64 v[120:121], v4 offset:1024
    ds_read_b64 v[122:123], v4 offset:1032
    ds_read_b128 v[76:79], v5 offset:1024
    v_mfma_f32_16x16x32_bf16 v[64:67], v[124:127], v[72:75], v[64:67]
    v_mfma_f32_16x16x32_bf16 v[60:63], v[124:127], v[68:71], v[60:63]
    ds_read_b64 v[124:125], v4 offset:512
    ds_read_b64 v[126:127], v4 offset:520
    ds_read_b128 v[72:75], v5 offset:512
    v_mfma_f32_16x16x32_bf16 v[64:67], v[16:19], v[68:71], v[64:67]
    ds_read_b64 v[16:17], v4 offset:0
    ds_read_b64 v[18:19], v4 offset:8
    ds_read_b128 v[68:71], v5 offset:0
    s_waitcnt lgkmcnt(15)
    v_mfma_f32_16x16x32_bf16 v[64:67], v[100:103], v[96:99], v[64:67]
    s_waitcnt lgkmcnt(15)
    v_mfma_f32_16x16x32_bf16 v[60:63], v[100:103], v[92:95], v[60:63]
    s_waitcnt lgkmcnt(15)
    v_mfma_f32_16x16x32_bf16 v[56:59], v[100:103], v[88:91], v[56:59]
    s_waitcnt lgkmcnt(12)
    v_mfma_f32_16x16x32_bf16 v[52:55], v[100:103], v[84:87], v[52:55]
    s_waitcnt lgkmcnt(9)
    v_mfma_f32_16x16x32_bf16 v[48:51], v[100:103], v[80:83], v[48:51]
    s_waitcnt lgkmcnt(6)
    v_mfma_f32_16x16x32_bf16 v[44:47], v[100:103], v[76:79], v[44:47]
    s_waitcnt lgkmcnt(3)
    v_mfma_f32_16x16x32_bf16 v[40:43], v[100:103], v[72:75], v[40:43]
    s_waitcnt lgkmcnt(0)
    v_mfma_f32_16x16x32_bf16 v[36:39], v[100:103], v[68:71], v[36:39]
    v_mfma_f32_16x16x32_bf16 v[64:67], v[104:107], v[92:95], v[64:67]
    v_mfma_f32_16x16x32_bf16 v[60:63], v[104:107], v[88:91], v[60:63]
    v_mfma_f32_16x16x32_bf16 v[56:59], v[104:107], v[84:87], v[56:59]
    v_mfma_f32_16x16x32_bf16 v[52:55], v[104:107], v[80:83], v[52:55]
    v_mfma_f32_16x16x32_bf16 v[48:51], v[104:107], v[76:79], v[48:51]
    v_mfma_f32_16x16x32_bf16 v[44:47], v[104:107], v[72:75], v[44:47]
    v_mfma_f32_16x16x32_bf16 v[40:43], v[104:107], v[68:71], v[40:43]
    v_mfma_f32_16x16x32_bf16 v[64:67], v[108:111], v[88:91], v[64:67]
    v_mfma_f32_16x16x32_bf16 v[60:63], v[108:111], v[84:87], v[60:63]
    v_mfma_f32_16x16x32_bf16 v[56:59], v[108:111], v[80:83], v[56:59]
    v_mfma_f32_16x16x32_bf16 v[52:55], v[108:111], v[76:79], v[52:55]
    v_mfma_f32_16x16x32_bf16 v[48:51], v[108:111], v[72:75], v[48:51]
    v_mfma_f32_16x16x32_bf16 v[44:47], v[108:111], v[68:71], v[44:47]
    v_mfma_f32_16x16x32_bf16 v[64:67], v[112:115], v[84:87], v[64:67]
    v_mfma_f32_16x16x32_bf16 v[60:63], v[112:115], v[80:83], v[60:63]
    v_mfma_f32_16x16x32_bf16 v[56:59], v[112:115], v[76:79], v[56:59]
    v_mfma_f32_16x16x32_bf16 v[52:55], v[112:115], v[72:75], v[52:55]
    v_mfma_f32_16x16x32_bf16 v[48:51], v[112:115], v[68:71], v[48:51]
    v_mfma_f32_16x16x32_bf16 v[64:67], v[116:119], v[80:83], v[64:67]
    v_mfma_f32_16x16x32_bf16 v[60:63], v[116:119], v[76:79], v[60:63]
    v_mfma_f32_16x16x32_bf16 v[56:59], v[116:119], v[72:75], v[56:59]
    v_mfma_f32_16x16x32_bf16 v[52:55], v[116:119], v[68:71], v[52:55]
    v_mfma_f32_16x16x32_bf16 v[64:67], v[120:123], v[76:79], v[64:67]
    v_mfma_f32_16x16x32_bf16 v[60:63], v[120:123], v[72:75], v[60:63]
    v_mfma_f32_16x16x32_bf16 v[56:59], v[120:123], v[68:71], v[56:59]
    v_mfma_f32_16x16x32_bf16 v[64:67], v[124:127], v[72:75], v[64:67]
    v_mfma_f32_16x16x32_bf16 v[60:63], v[124:127], v[68:71], v[60:63]
    v_mfma_f32_16x16x32_bf16 v[64:67], v[16:19], v[68:71], v[64:67]
    v_lshrrev_b32 v4, 2, v7
    v_mul_u32_u24 v4, 576, v4
    v_and_b32 v5, 3, v7
    v_lshl_add_u32 v4, v5, 3, v4
    v_mul_u32_u24 v5, 96, v8
    v_add_u32 v4, v4, v5
    v_mul_u32_u24 v5, 55296, v8
    v_lshl_add_u32 v5, v7, 4, v5
    ds_read_b64_tr_b16 v[100:101], v4 offset:21248
    ds_read_b64_tr_b16 v[102:103], v4 offset:30464
    ds_read_b64_tr_b16 v[104:105], v4 offset:21280
    ds_read_b64_tr_b16 v[106:107], v4 offset:30496
    ds_read_b64_tr_b16 v[108:109], v4 offset:21312
    ds_read_b64_tr_b16 v[110:111], v4 offset:30528
    s_waitcnt lgkmcnt(4)
    buffer_store_dwordx4 v[100:103], v5, s[4:7], s99 offen offset:0 sc1
    s_waitcnt lgkmcnt(2)
    buffer_store_dwordx4 v[104:107], v5, s[4:7], s99 offen offset:1024 sc1
    s_waitcnt lgkmcnt(0)
    buffer_store_dwordx4 v[108:111], v5, s[4:7], s99 offen offset:2048 sc1
    s_cmp_ge_u32 s75, 2
    s_cbranch_scc1 A_wdone
    s_add_u32 s100, s99, 221184
    ds_read_b64_tr_b16 v[112:113], v4 offset:21632
    ds_read_b64_tr_b16 v[114:115], v4 offset:30848
    ds_read_b64_tr_b16 v[116:117], v4 offset:21664
    ds_read_b64_tr_b16 v[118:119], v4 offset:30880
    ds_read_b64_tr_b16 v[120:121], v4 offset:21696
    ds_read_b64_tr_b16 v[122:123], v4 offset:30912
    s_waitcnt lgkmcnt(4)
    buffer_store_dwordx4 v[112:115], v5, s[4:7], s100 offen offset:0 sc1
    s_waitcnt lgkmcnt(2)
    buffer_store_dwordx4 v[116:119], v5, s[4:7], s100 offen offset:1024 sc1
    s_waitcnt lgkmcnt(0)
    buffer_store_dwordx4 v[120:123], v5, s[4:7], s100 offen offset:2048 sc1
A_wdone:
    s_barrier
    v_lshl_add_u32 v4, v6, 2, v9
    v_bfe_u32 v5, v4, 3, 2
    v_xor_b32 v4, v4, v5
    v_lshlrev_b32 v4, 4, v4
    v_lshl_add_u32 v4, v8, 13, v4
    ds_write_b128 v4, v[36:39] offset:0
    ds_write_b128 v4, v[40:43] offset:1024
    ds_write_b128 v4, v[44:47] offset:2048
    ds_write_b128 v4, v[48:51] offset:3072
    ds_write_b128 v4, v[52:55] offset:4096
    ds_write_b128 v4, v[56:59] offset:5120
    ds_write_b128 v4, v[60:63] offset:6144
    ds_write_b128 v4, v[64:67] offset:7168
    v_lshlrev_b32 v4, 1, v0
    v_bfe_u32 v5, v4, 3, 2
    v_xor_b32 v16, v4, v5
    v_lshlrev_b32 v16, 4, v16
    v_xor_b32 v17, 16, v16
    s_waitcnt lgkmcnt(0)
    s_barrier
    ds_read_b128 v[68:71], v16 offset:0
    ds_read_b128 v[72:75], v17 offset:0
    ds_read_b128 v[76:79], v16 offset:8192
    ds_read_b128 v[80:83], v17 offset:8192
    ds_read_b128 v[84:87], v16 offset:16384
    ds_read_b128 v[88:91], v17 offset:16384
    ds_read_b128 v[92:95], v16 offset:24576
    ds_read_b128 v[96:99], v17 offset:24576
    s_lshl_b32 s26, s3, 5
    s_add_u32 s26, s26, 2490368
    v_lshrrev_b32 v3, 1, v0
    v_mul_u32_u24 v3, 18432, v3
    v_and_b32 v4, 1, v0
    v_lshl_add_u32 v3, v4, 4, v3
    v_mov_b32 v18, s74
    v_mov_b32 v20, s73
    v_lshlrev_b32 v36, 16, v24
    v_and_b32 v37, 0xffff0000, v24
    v_lshlrev_b32 v44, 16, v10
    v_and_b32 v45, 0xffff0000, v10
    v_lshlrev_b32 v38, 16, v25
    v_and_b32 v39, 0xffff0000, v25
    v_lshlrev_b32 v46, 16, v11
    v_and_b32 v47, 0xffff0000, v11
    v_lshlrev_b32 v40, 16, v26
    v_and_b32 v41, 0xffff0000, v26
    v_lshlrev_b32 v48, 16, v12
    v_and_b32 v49, 0xffff0000, v12
    v_lshlrev_b32 v42, 16, v27
    v_and_b32 v43, 0xffff0000, v27
    v_lshlrev_b32 v50, 16, v13
    v_and_b32 v51, 0xffff0000, v13
    s_waitcnt lgkmcnt(0)
    v_pk_add_f32 v[68:69], v[68:69], v[76:77]
    v_pk_add_f32 v[70:71], v[70:71], v[78:79]
    v_pk_add_f32 v[72:73], v[72:73], v[80:81]
    v_pk_add_f32 v[74:75], v[74:75], v[82:83]
    v_pk_add_f32 v[84:85], v[84:85], v[92:93]
    v_pk_add_f32 v[86:87], v[86:87], v[94:95]
    v_pk_add_f32 v[88:89], v[88:89], v[96:97]
    v_pk_add_f32 v[90:91], v[90:91], v[98:99]
    v_pk_add_f32 v[68:69], v[68:69], v[84:85]
    v_pk_add_f32 v[70:71], v[70:71], v[86:87]
    v_pk_add_f32 v[72:73], v[72:73], v[88:89]
    v_pk_add_f32 v[74:75], v[74:75], v[90:91]
    v_pk_fma_f32 v[68:69], v[36:37], v[18:19], v[68:69] op_sel_hi:[1,0,1]
    v_pk_fma_f32 v[70:71], v[38:39], v[18:19], v[70:71] op_sel_hi:[1,0,1]
    v_pk_fma_f32 v[72:73], v[40:41], v[18:19], v[72:73] op_sel_hi:[1,0,1]
    v_pk_fma_f32 v[74:75], v[42:43], v[18:19], v[74:75] op_sel_hi:[1,0,1]
    v_pk_fma_f32 v[68:69], v[68:69], v[20:21], v[44:45] op_sel_hi:[1,0,1]
    v_pk_fma_f32 v[70:71], v[70:71], v[20:21], v[46:47] op_sel_hi:[1,0,1]
    v_pk_fma_f32 v[72:73], v[72:73], v[20:21], v[48:49] op_sel_hi:[1,0,1]
    v_pk_fma_f32 v[74:75], v[74:75], v[20:21], v[50:51] op_sel_hi:[1,0,1]
    v_cvt_pk_bf16_f32 v28, v68, v69
    v_cvt_pk_bf16_f32 v29, v70, v71
    v_cvt_pk_bf16_f32 v30, v72, v73
    v_cvt_pk_bf16_f32 v31, v74, v75
    buffer_store_dwordx4 v[28:31], v3, s[4:7], s26 offen
    s_endpgm
A_coll:
    s_cmp_lg_u32 s3, 54
    s_cbranch_scc1 A_done
    s_cmp_lg_u32 s75, 0
    s_cbranch_scc1 A_done
    s_waitcnt lgkmcnt(0)
    s_mov_b32 s4, s22
    s_and_b32 s5, s23, 0xffff
    s_mov_b32 s6, 268435456
    s_mov_b32 s7, 0x20000
    s_mov_b32 s16, s20
    s_and_b32 s17, s21, 0xffff
    s_mov_b32 s18, 256
    s_mov_b32 s19, 0x20000
    s_cmp_lg_u32 s75, 0
    s_cbranch_scc1 go_9
    s_mov_b32 s70, 1048576
    v_mov_b32 v2, 0
    v_min_u32 v11, 58, v7
    v_lshlrev_b32 v11, 3, v11
    s_mov_b32 s71, 90112
poll_10:
    buffer_load_dword v10, v2, s[16:19], 0 offen sc1
    buffer_load_dwordx2 v[12:13], v11, s[4:7], s71 offen sc1
    s_waitcnt vmcnt(0)
    v_xor_b32 v12, v12, v10
    v_xor_b32 v13, v13, v10
    v_or_b32 v12, v12, v13
    v_cmp_eq_u32 vcc, 0, v10
    s_nop 1
    v_cndmask_b32 v12, v12, 1, vcc
    v_cmp_ne_u32 vcc, 0, v12
    s_cbranch_vccz go_9
    s_sub_u32 s70, s70, 1
    s_cmp_eq_u32 s70, 0
    s_cbranch_scc1 go_9
    s_sleep 0
    s_branch poll_10
go_9:
    s_barrier
    v_mov_b32 v3, 1
    v_mov_b32 v2, 0
    s_mov_b64 exec, 1
    buffer_store_dword v3, v2, s[16:19], 0 offen offset:128 sc1
    s_endpgm
A_done:
    s_endpgm
.globl mlp_kernel
.p2align 8
.type mlp_kernel,@function
mlp_kernel:
    s_cmp_ge_u32 s2, 256
    s_cbranch_scc1 C_done
    s_load_dwordx2 s[20:21], s[0:1], 144
    s_load_dwordx2 s[22:23], s[0:1], 88
    s_load_dwordx2 s[52:53], s[0:1], 104
    s_load_dwordx2 s[54:55], s[0:1], 128
    s_setprio 2
    v_lshrrev_b32 v7, 6, v0
    v_and_b32 v0, 63, v0
    v_readfirstlane_b32 s3, v7
    s_and_b32 s26, s2, 7
    s_lshr_b32 s27, s2, 3
    s_and_b32 s24, s26, 3
    s_lshl_b32 s24, s24, 1
    s_and_b32 s25, s27, 1
    s_add_u32 s24, s24, s25
    s_lshr_b32 s42, s27, 1
    s_lshr_b32 s25, s26, 2
    s_mul_i32 s25, s25, 16
    s_add_u32 s25, s25, s42
    v_lshlrev_b32 v1, 4, v0
    s_lshr_b32 s27, s3, 2
    s_mov_b32 s65, s27
    s_and_b32 s26, s3, 3
    s_lshl_b32 s28, s25, 2
    s_add_u32 s28, s28, s26
    s_mul_i32 s28, s28, 18432
    s_mul_i32 s29, s65, 6144
    s_add_u32 s28, s28, s29
    s_add_u32 s28, s28, 2490368
    s_add_u32 s30, s28, 4096
    s_mul_i32 s29, s3, 6144
    s_add_u32 s29, s29, 73728
    s_add_u32 s31, s29, 4096
    s_min_u32 s34, s3, 4
    s_lshl_b32 s34, s34, 10
    v_mov_b32 v8, 0
    v_mov_b32 v9, 155648
    v_and_b32 v2, 15, v0
    v_lshl_add_u32 v9, v2, 2, v9
    ds_write_b32 v9, v8
    v_lshrrev_b32 v7, 4, v0
    v_lshlrev_b32 v2, 3, v7
    s_mul_i32 s32, s24, 1152
    s_mul_i32 s33, s3, 96
    s_add_u32 s32, s32, s33
    s_mov_b32 m0, s29
    s_waitcnt lgkmcnt(0)
    s_mov_b32 s4, s20
    s_and_b32 s5, s21, 0xffff
    s_mov_b32 s6, 268435456
    s_mov_b32 s7, 0x20000
    s_mov_b32 s8, s22
    s_and_b32 s9, s23, 0xffff
    s_mov_b32 s10, 9216
    s_mov_b32 s11, 0x20000
    buffer_load_dwordx4 v1, s[4:7], s28 offen offset:0  lds
    buffer_load_dwordx4 v1, s[4:7], s28 offen offset:1024  lds
    buffer_load_dwordx4 v1, s[4:7], s28 offen offset:2048  lds
    buffer_load_dwordx4 v1, s[4:7], s28 offen offset:3072  lds
    s_mov_b32 m0, s31
    s_mul_i32 s31, s24, 12
    buffer_load_dwordx4 v1, s[4:7], s30 offen offset:0  lds
    buffer_load_dwordx4 v1, s[4:7], s30 offen offset:1024  lds
    s_add_u32 m0, s34, 150528
    s_add_u32 s34, s34, 6912
    buffer_load_dwordx4 v1, s[4:7], s34 offen  lds
    buffer_load_dwordx2 v[150:151], v2, s[8:11], s32 offen offset:0
    buffer_load_dwordx2 v[154:155], v2, s[8:11], s32 offen offset:32
    buffer_load_dwordx2 v[158:159], v2, s[8:11], s32 offen offset:64
    s_add_u32 s31, s31, s3
    s_mul_i32 s31, s31, 55296
    s_add_u32 s40, s31, 7208960
    s_add_u32 s41, s31, 12517376
    v_lshlrev_b32 v3, 3, v0
    v_add_u32 v3, s29, v3
    v_and_b32 v4, 15, v0
    s_lshl_b32 s31, s26, 7
    s_add_u32 s31, s31, 147456
    v_lshlrev_b32 v4, 3, v4
    v_add_u32 v4, s31, v4
    s_lshl_b32 s31, s65, 9
    v_add_u32 v5, s31, v4
    s_mul_i32 s31, s65, 768
    s_add_u32 s31, s31, 150528
    v_lshlrev_b32 v2, 4, v7
    v_add_u32 v2, s31, v2
    s_mul_i32 s32, s25, 18
    s_mul_i32 s33, s65, 6
    s_add_u32 s32, s32, s33
    s_lshl_b32 s32, s32, 2
    s_add_u32 s32, s32, s26
    s_lshl_b32 s32, s32, 10
    s_add_u32 s32, s32, 4849664
    s_mul_i32 s31, s65, 24576
    s_lshl_b32 s33, s26, 10
    s_add_u32 s31, s31, s33
    v_add_u32 v87, s31, v1
    s_waitcnt vmcnt(9)
    ds_read_b64_tr_b16 v[56:57], v3 offset:0
    ds_read_b64_tr_b16 v[58:59], v3 offset:512
    s_waitcnt lgkmcnt(0)
    ds_write_b128 v87, v[56:59] offset:0
    v_lshlrev_b32 v8, 16, v56
    v_and_b32 v9, 0xffff0000, v56
    v_lshlrev_b32 v10, 16, v57
    v_and_b32 v11, 0xffff0000, v57
    v_lshlrev_b32 v12, 16, v58
    v_and_b32 v13, 0xffff0000, v58
    v_lshlrev_b32 v14, 16, v59
    v_and_b32 v15, 0xffff0000, v59
    v_pk_mul_f32 v[82:83], v[8:9], v[8:9]
    v_pk_add_f32 v[80:81], v[8:9], v[10:11]
    v_pk_mul_f32 v[84:85], v[10:11], v[10:11]
    v_pk_add_f32 v[80:81], v[80:81], v[12:13]
    v_pk_fma_f32 v[82:83], v[12:13], v[12:13], v[82:83]
    v_pk_add_f32 v[80:81], v[80:81], v[14:15]
    v_pk_fma_f32 v[84:85], v[14:15], v[14:15], v[84:85]
    s_waitcnt vmcnt(8)
    ds_read_b64_tr_b16 v[60:61], v3 offset:1024
    ds_read_b64_tr_b16 v[62:63], v3 offset:1536
    s_waitcnt lgkmcnt(0)
    ds_write_b128 v87, v[60:63] offset:4096
    v_lshlrev_b32 v16, 16, v60
    v_and_b32 v17, 0xffff0000, v60
    v_lshlrev_b32 v18, 16, v61
    v_and_b32 v19, 0xffff0000, v61
    v_lshlrev_b32 v20, 16, v62
    v_and_b32 v21, 0xffff0000, v62
    v_lshlrev_b32 v22, 16, v63
    v_and_b32 v23, 0xffff0000, v63
    v_pk_add_f32 v[80:81], v[80:81], v[16:17]
    v_pk_fma_f32 v[82:83], v[16:17], v[16:17], v[82:83]
    v_pk_add_f32 v[80:81], v[80:81], v[18:19]
    v_pk_fma_f32 v[84:85], v[18:19], v[18:19], v[84:85]
    v_pk_add_f32 v[80:81], v[80:81], v[20:21]
    v_pk_fma_f32 v[82:83], v[20:21], v[20:21], v[82:83]
    v_pk_add_f32 v[80:81], v[80:81], v[22:23]
    v_pk_fma_f32 v[84:85], v[22:23], v[22:23], v[84:85]
    s_waitcnt vmcnt(7)
    ds_read_b64_tr_b16 v[64:65], v3 offset:2048
    ds_read_b64_tr_b16 v[66:67], v3 offset:2560
    s_waitcnt lgkmcnt(0)
    ds_write_b128 v87, v[64:67] offset:8192
    v_lshlrev_b32 v24, 16, v64
    v_and_b32 v25, 0xffff0000, v64
    v_lshlrev_b32 v26, 16, v65
    v_and_b32 v27, 0xffff0000, v65
    v_lshlrev_b32 v28, 16, v66
    v_and_b32 v29, 0xffff0000, v66
    v_lshlrev_b32 v30, 16, v67
    v_and_b32 v31, 0xffff0000, v67
    v_pk_add_f32 v[80:81], v[80:81], v[24:25]
    v_pk_fma_f32 v[82:83], v[24:25], v[24:25], v[82:83]
    v_pk_add_f32 v[80:81], v[80:81], v[26:27]
    v_pk_fma_f32 v[84:85], v[26:27], v[26:27], v[84:85]
    v_pk_add_f32 v[80:81], v[80:81], v[28:29]
    v_pk_fma_f32 v[82:83], v[28:29], v[28:29], v[82:83]
    v_pk_add_f32 v[80:81], v[80:81], v[30:31]
    v_pk_fma_f32 v[84:85], v[30:31], v[30:31], v[84:85]
    s_waitcnt vmcnt(6)
    ds_read_b64_tr_b16 v[68:69], v3 offset:3072
    ds_read_b64_tr_b16 v[70:71], v3 offset:3584
    s_waitcnt lgkmcnt(0)
    ds_write_b128 v87, v[68:71] offset:12288
    v_lshlrev_b32 v32, 16, v68
    v_and_b32 v33, 0xffff0000, v68
    v_lshlrev_b32 v34, 16, v69
    v_and_b32 v35, 0xffff0000, v69
    v_lshlrev_b32 v36, 16, v70
    v_and_b32 v37, 0xffff0000, v70
    v_lshlrev_b32 v38, 16, v71
    v_and_b32 v39, 0xffff0000, v71
    v_pk_add_f32 v[80:81], v[80:81], v[32:33]
    v_pk_fma_f32 v[82:83], v[32:33], v[32:33], v[82:83]
    v_pk_add_f32 v[80:81], v[80:81], v[34:35]
    v_pk_fma_f32 v[84:85], v[34:35], v[34:35], v[84:85]
    v_pk_add_f32 v[80:81], v[80:81], v[36:37]
    v_pk_fma_f32 v[82:83], v[36:37], v[36:37], v[82:83]
    v_pk_add_f32 v[80:81], v[80:81], v[38:39]
    v_pk_fma_f32 v[84:85], v[38:39], v[38:39], v[84:85]
    s_waitcnt vmcnt(5)
    ds_read_b64_tr_b16 v[72:73], v3 offset:4096
    ds_read_b64_tr_b16 v[74:75], v3 offset:4608
    s_waitcnt lgkmcnt(0)
    ds_write_b128 v87, v[72:75] offset:16384
    v_lshlrev_b32 v40, 16, v72
    v_and_b32 v41, 0xffff0000, v72
    v_lshlrev_b32 v42, 16, v73
    v_and_b32 v43, 0xffff0000, v73
    v_lshlrev_b32 v44, 16, v74
    v_and_b32 v45, 0xffff0000, v74
    v_lshlrev_b32 v46, 16, v75
    v_and_b32 v47, 0xffff0000, v75
    v_pk_add_f32 v[80:81], v[80:81], v[40:41]
    v_pk_fma_f32 v[82:83], v[40:41], v[40:41], v[82:83]
    v_pk_add_f32 v[80:81], v[80:81], v[42:43]
    v_pk_fma_f32 v[84:85], v[42:43], v[42:43], v[84:85]
    v_pk_add_f32 v[80:81], v[80:81], v[44:45]
    v_pk_fma_f32 v[82:83], v[44:45], v[44:45], v[82:83]
    v_pk_add_f32 v[80:81], v[80:81], v[46:47]
    v_pk_fma_f32 v[84:85], v[46:47], v[46:47], v[84:85]
    s_waitcnt vmcnt(4)
    ds_read_b64_tr_b16 v[76:77], v3 offset:5120
    ds_read_b64_tr_b16 v[78:79], v3 offset:5632
    s_waitcnt lgkmcnt(0)
    ds_write_b128 v87, v[76:79] offset:20480
    v_lshlrev_b32 v48, 16, v76
    v_and_b32 v49, 0xffff0000, v76
    v_lshlrev_b32 v50, 16, v77
    v_and_b32 v51, 0xffff0000, v77
    v_lshlrev_b32 v52, 16, v78
    v_and_b32 v53, 0xffff0000, v78
    v_lshlrev_b32 v54, 16, v79
    v_and_b32 v55, 0xffff0000, v79
    v_pk_add_f32 v[80:81], v[80:81], v[48:49]
    v_pk_fma_f32 v[82:83], v[48:49], v[48:49], v[82:83]
    v_pk_add_f32 v[80:81], v[80:81], v[50:51]
    v_pk_fma_f32 v[84:85], v[50:51], v[50:51], v[84:85]
    v_pk_add_f32 v[80:81], v[80:81], v[52:53]
    v_pk_fma_f32 v[82:83], v[52:53], v[52:53], v[82:83]
    v_pk_add_f32 v[80:81], v[80:81], v[54:55]
    v_pk_fma_f32 v[84:85], v[54:55], v[54:55], v[84:85]
    s_mul_i32 s61, s24, 3
    s_min_u32 s33, s26, 2
    s_add_u32 s61, s61, s33
    s_lshr_b32 s33, s61, 2
    s_lshl_b32 s33, s33, 12
    s_and_b32 s34, s61, 1
    s_lshl_b32 s34, s34, 11
    s_add_u32 s33, s33, s34
    s_bfe_u32 s34, s61, 0x10001
    s_lshl_b32 s34, s34, 3
    s_add_u32 s33, s33, s34
    s_mul_i32 s34, s27, 24576
    s_add_u32 s33, s33, s34
    v_add_u32 v166, s33, v1
    v_pk_add_f32 v[82:83], v[82:83], v[84:85]
    v_add_f32 v80, v80, v81
    v_add_f32 v81, v82, v83
    v_mov_b32 v82, v80
    v_mov_b32 v83, v81
    s_nop 0
    v_permlane16_swap_b32 v80, v82
    v_permlane16_swap_b32 v81, v83
    v_pk_add_f32 v[80:81], v[80:81], v[82:83]
    s_nop 0
    v_mov_b32 v82, v80
    v_mov_b32 v83, v81
    s_nop 0
    v_permlane32_swap_b32 v80, v82
    v_permlane32_swap_b32 v81, v83
    v_pk_add_f32 v[80:81], v[80:81], v[82:83]
    ds_write_b64 v5, v[80:81] offset:0
    s_waitcnt vmcnt(3) lgkmcnt(0)
    s_barrier
    ds_read_b64 v[80:81], v4 offset:0
    ds_read_b64 v[82:83], v4 offset:512
    ds_read_b64 v[84:85], v4 offset:1024
    ds_read_b64 v[162:163], v166 offset:0
    ds_read_b64 v[164:165], v166 offset:1024
    ds_read_b128 v[56:59], v2 offset:2304
    ds_read_b128 v[60:63], v2 offset:0
    ds_read_b128 v[64:67], v2 offset:2368
    ds_read_b128 v[68:71], v2 offset:64
    ds_read_b128 v[72:75], v2 offset:2432
    ds_read_b128 v[76:79], v2 offset:128
    buffer_load_dwordx4 v[88:91], v1, s[4:7], s40 offen offset:0
    buffer_load_dwordx4 v[92:95], v1, s[4:7], s40 offen offset:1024
    buffer_load_dwordx4 v[96:99], v1, s[4:7], s40 offen offset:2048
    s_add_u32 s40, s40, 3072
    s_waitcnt lgkmcnt(8)
    v_pk_add_f32 v[6:7], v[80:81], v[82:83]
    s_nop 0
    v_pk_add_f32 v[6:7], v[6:7], v[84:85]
    s_nop 0
    v_mul_f32 v6, 0x3ae38e39, v6
    v_mul_f32 v7, 0x3ae38e39, v7
    v_fma_f32 v7, -v6, v6, v7
    v_max_f32 v7, 0, v7
    v_cvt_pk_bf16_f32 v6, v6, v6
    v_and_b32 v6, 0xffff0000, v6
    v_cvt_pk_bf16_f32 v7, v7, v7
    v_and_b32 v7, 0xffff0000, v7
    v_add_f32 v7, 0x3727c5ac, v7
    v_cvt_pk_bf16_f32 v7, v7, v7
    v_and_b32 v7, 0xffff0000, v7
    v_sqrt_f32 v7, v7
    s_nop 0
    v_cvt_pk_bf16_f32 v7, v7, v7
    v_and_b32 v7, 0xffff0000, v7
    v_rcp_f32 v7, v7
    s_nop 0
    v_mul_f32 v86, v6, v7
    v_mov_b32 v6, v7
    s_waitcnt lgkmcnt(4)
    v_pk_fma_f32 v[8:9], v[8:9], v[6:7], v[86:87] op_sel_hi:[1,0,0] neg_lo:[0,0,1] neg_hi:[0,0,1]
    v_pk_fma_f32 v[10:11], v[10:11], v[6:7], v[86:87] op_sel_hi:[1,0,0] neg_lo:[0,0,1] neg_hi:[0,0,1]
    v_pk_fma_f32 v[8:9], v[8:9], v[56:57], v[60:61]
    v_pk_fma_f32 v[10:11], v[10:11], v[58:59], v[62:63]
    ds_read_b128 v[56:59], v2 offset:2496
    ds_read_b128 v[60:63], v2 offset:192
    v_pk_mul_f32 v[82:83], v[8:9], v[8:9]
    v_pk_add_f32 v[80:81], v[8:9], v[10:11]
    v_pk_mul_f32 v[84:85], v[10:11], v[10:11]
    s_waitcnt lgkmcnt(4)
    v_pk_fma_f32 v[12:13], v[12:13], v[6:7], v[86:87] op_sel_hi:[1,0,0] neg_lo:[0,0,1] neg_hi:[0,0,1]
    v_pk_fma_f32 v[14:15], v[14:15], v[6:7], v[86:87] op_sel_hi:[1,0,0] neg_lo:[0,0,1] neg_hi:[0,0,1]
    v_pk_fma_f32 v[12:13], v[12:13], v[64:65], v[68:69]
    v_pk_fma_f32 v[14:15], v[14:15], v[66:67], v[70:71]
    ds_read_b128 v[64:67], v2 offset:2560
    ds_read_b128 v[68:71], v2 offset:256
    buffer_load_dwordx4 v[100:103], v1, s[4:7], s40 offen offset:0
    v_pk_add_f32 v[80:81], v[80:81], v[12:13]
    v_pk_fma_f32 v[82:83], v[12:13], v[12:13], v[82:83]
    v_pk_add_f32 v[80:81], v[80:81], v[14:15]
    v_pk_fma_f32 v[84:85], v[14:15], v[14:15], v[84:85]
    s_waitcnt lgkmcnt(4)
    v_pk_fma_f32 v[16:17], v[16:17], v[6:7], v[86:87] op_sel_hi:[1,0,0] neg_lo:[0,0,1] neg_hi:[0,0,1]
    v_pk_fma_f32 v[18:19], v[18:19], v[6:7], v[86:87] op_sel_hi:[1,0,0] neg_lo:[0,0,1] neg_hi:[0,0,1]
    v_pk_fma_f32 v[16:17], v[16:17], v[72:73], v[76:77]
    v_pk_fma_f32 v[18:19], v[18:19], v[74:75], v[78:79]
    ds_read_b128 v[72:75], v2 offset:2624
    ds_read_b128 v[76:79], v2 offset:320
    v_pk_add_f32 v[80:81], v[80:81], v[16:17]
    v_pk_fma_f32 v[82:83], v[16:17], v[16:17], v[82:83]
    v_pk_add_f32 v[80:81], v[80:81], v[18:19]
    v_pk_fma_f32 v[84:85], v[18:19], v[18:19], v[84:85]
    s_waitcnt lgkmcnt(4)
    v_pk_fma_f32 v[20:21], v[20:21], v[6:7], v[86:87] op_sel_hi:[1,0,0] neg_lo:[0,0,1] neg_hi:[0,0,1]
    v_pk_fma_f32 v[22:23], v[22:23], v[6:7], v[86:87] op_sel_hi:[1,0,0] neg_lo:[0,0,1] neg_hi:[0,0,1]
    v_pk_fma_f32 v[20:21], v[20:21], v[56:57], v[60:61]
    v_pk_fma_f32 v[22:23], v[22:23], v[58:59], v[62:63]
    ds_read_b128 v[56:59], v2 offset:2688
    ds_read_b128 v[60:63], v2 offset:384
    buffer_load_dwordx4 v[104:107], v1, s[4:7], s40 offen offset:1024
    v_pk_add_f32 v[80:81], v[80:81], v[20:21]
    v_pk_fma_f32 v[82:83], v[20:21], v[20:21], v[82:83]
    v_pk_add_f32 v[80:81], v[80:81], v[22:23]
    v_pk_fma_f32 v[84:85], v[22:23], v[22:23], v[84:85]
    s_waitcnt lgkmcnt(4)
    v_pk_fma_f32 v[24:25], v[24:25], v[6:7], v[86:87] op_sel_hi:[1,0,0] neg_lo:[0,0,1] neg_hi:[0,0,1]
    v_pk_fma_f32 v[26:27], v[26:27], v[6:7], v[86:87] op_sel_hi:[1,0,0] neg_lo:[0,0,1] neg_hi:[0,0,1]
    v_pk_fma_f32 v[24:25], v[24:25], v[64:65], v[68:69]
    v_pk_fma_f32 v[26:27], v[26:27], v[66:67], v[70:71]
    ds_read_b128 v[64:67], v2 offset:2752
    ds_read_b128 v[68:71], v2 offset:448
    v_pk_add_f32 v[80:81], v[80:81], v[24:25]
    v_pk_fma_f32 v[82:83], v[24:25], v[24:25], v[82:83]
    v_pk_add_f32 v[80:81], v[80:81], v[26:27]
    v_pk_fma_f32 v[84:85], v[26:27], v[26:27], v[84:85]
    s_waitcnt lgkmcnt(4)
    v_pk_fma_f32 v[28:29], v[28:29], v[6:7], v[86:87] op_sel_hi:[1,0,0] neg_lo:[0,0,1] neg_hi:[0,0,1]
    v_pk_fma_f32 v[30:31], v[30:31], v[6:7], v[86:87] op_sel_hi:[1,0,0] neg_lo:[0,0,1] neg_hi:[0,0,1]
    v_pk_fma_f32 v[28:29], v[28:29], v[72:73], v[76:77]
    v_pk_fma_f32 v[30:31], v[30:31], v[74:75], v[78:79]
    ds_read_b128 v[72:75], v2 offset:2816
    ds_read_b128 v[76:79], v2 offset:512
    buffer_load_dwordx4 v[108:111], v1, s[4:7], s40 offen offset:2048
    s_add_u32 s40, s40, 3072
    v_pk_add_f32 v[80:81], v[80:81], v[28:29]
    v_pk_fma_f32 v[82:83], v[28:29], v[28:29], v[82:83]
    v_pk_add_f32 v[80:81], v[80:81], v[30:31]
    v_pk_fma_f32 v[84:85], v[30:31], v[30:31], v[84:85]
    s_waitcnt lgkmcnt(4)
    v_pk_fma_f32 v[32:33], v[32:33], v[6:7], v[86:87] op_sel_hi:[1,0,0] neg_lo:[0,0,1] neg_hi:[0,0,1]
    v_pk_fma_f32 v[34:35], v[34:35], v[6:7], v[86:87] op_sel_hi:[1,0,0] neg_lo:[0,0,1] neg_hi:[0,0,1]
    v_pk_fma_f32 v[32:33], v[32:33], v[56:57], v[60:61]
    v_pk_fma_f32 v[34:35], v[34:35], v[58:59], v[62:63]
    ds_read_b128 v[56:59], v2 offset:2880
    ds_read_b128 v[60:63], v2 offset:576
    v_pk_add_f32 v[80:81], v[80:81], v[32:33]
    v_pk_fma_f32 v[82:83], v[32:33], v[32:33], v[82:83]
    v_pk_add_f32 v[80:81], v[80:81], v[34:35]
    v_pk_fma_f32 v[84:85], v[34:35], v[34:35], v[84:85]
    s_waitcnt lgkmcnt(4)
    v_pk_fma_f32 v[36:37], v[36:37], v[6:7], v[86:87] op_sel_hi:[1,0,0] neg_lo:[0,0,1] neg_hi:[0,0,1]
    v_pk_fma_f32 v[38:39], v[38:39], v[6:7], v[86:87] op_sel_hi:[1,0,0] neg_lo:[0,0,1] neg_hi:[0,0,1]
    v_pk_fma_f32 v[36:37], v[36:37], v[64:65], v[68:69]
    v_pk_fma_f32 v[38:39], v[38:39], v[66:67], v[70:71]
    ds_read_b128 v[64:67], v2 offset:2944
    ds_read_b128 v[68:71], v2 offset:640
    buffer_load_dwordx4 v[112:115], v1, s[4:7], s40 offen offset:0
    v_pk_add_f32 v[80:81], v[80:81], v[36:37]
    v_pk_fma_f32 v[82:83], v[36:37], v[36:37], v[82:83]
    v_pk_add_f32 v[80:81], v[80:81], v[38:39]
    v_pk_fma_f32 v[84:85], v[38:39], v[38:39], v[84:85]
    s_waitcnt lgkmcnt(4)
    v_pk_fma_f32 v[40:41], v[40:41], v[6:7], v[86:87] op_sel_hi:[1,0,0] neg_lo:[0,0,1] neg_hi:[0,0,1]
    v_pk_fma_f32 v[42:43], v[42:43], v[6:7], v[86:87] op_sel_hi:[1,0,0] neg_lo:[0,0,1] neg_hi:[0,0,1]
    v_pk_fma_f32 v[40:41], v[40:41], v[72:73], v[76:77]
    v_pk_fma_f32 v[42:43], v[42:43], v[74:75], v[78:79]
    ds_read_b128 v[72:75], v2 offset:3008
    ds_read_b128 v[76:79], v2 offset:704
    v_pk_add_f32 v[80:81], v[80:81], v[40:41]
    v_pk_fma_f32 v[82:83], v[40:41], v[40:41], v[82:83]
    v_pk_add_f32 v[80:81], v[80:81], v[42:43]
    v_pk_fma_f32 v[84:85], v[42:43], v[42:43], v[84:85]
    s_waitcnt lgkmcnt(4)
    v_pk_fma_f32 v[44:45], v[44:45], v[6:7], v[86:87] op_sel_hi:[1,0,0] neg_lo:[0,0,1] neg_hi:[0,0,1]
    v_pk_fma_f32 v[46:47], v[46:47], v[6:7], v[86:87] op_sel_hi:[1,0,0] neg_lo:[0,0,1] neg_hi:[0,0,1]
    v_pk_fma_f32 v[44:45], v[44:45], v[56:57], v[60:61]
    v_pk_fma_f32 v[46:47], v[46:47], v[58:59], v[62:63]
    buffer_load_dwordx4 v[116:119], v1, s[4:7], s40 offen offset:1024
    v_pk_add_f32 v[80:81], v[80:81], v[44:45]
    v_pk_fma_f32 v[82:83], v[44:45], v[44:45], v[82:83]
    v_pk_add_f32 v[80:81], v[80:81], v[46:47]
    v_pk_fma_f32 v[84:85], v[46:47], v[46:47], v[84:85]
    s_waitcnt lgkmcnt(2)
    v_pk_fma_f32 v[48:49], v[48:49], v[6:7], v[86:87] op_sel_hi:[1,0,0] neg_lo:[0,0,1] neg_hi:[0,0,1]
    v_pk_fma_f32 v[50:51], v[50:51], v[6:7], v[86:87] op_sel_hi:[1,0,0] neg_lo:[0,0,1] neg_hi:[0,0,1]
    v_pk_fma_f32 v[48:49], v[48:49], v[64:65], v[68:69]
    v_pk_fma_f32 v[50:51], v[50:51], v[66:67], v[70:71]
    v_pk_add_f32 v[80:81], v[80:81], v[48:49]
    v_pk_fma_f32 v[82:83], v[48:49], v[48:49], v[82:83]
    v_pk_add_f32 v[80:81], v[80:81], v[50:51]
    v_pk_fma_f32 v[84:85], v[50:51], v[50:51], v[84:85]
    s_waitcnt lgkmcnt(0)
    v_pk_fma_f32 v[52:53], v[52:53], v[6:7], v[86:87] op_sel_hi:[1,0,0] neg_lo:[0,0,1] neg_hi:[0,0,1]
    v_pk_fma_f32 v[54:55], v[54:55], v[6:7], v[86:87] op_sel_hi:[1,0,0] neg_lo:[0,0,1] neg_hi:[0,0,1]
    v_pk_fma_f32 v[52:53], v[52:53], v[72:73], v[76:77]
    v_pk_fma_f32 v[54:55], v[54:55], v[74:75], v[78:79]
    buffer_load_dwordx4 v[120:123], v1, s[4:7], s40 offen offset:2048
    s_add_u32 s40, s40, 3072
    v_pk_add_f32 v[80:81], v[80:81], v[52:53]
    v_pk_fma_f32 v[82:83], v[52:53], v[52:53], v[82:83]
    v_pk_add_f32 v[80:81], v[80:81], v[54:55]
    v_pk_fma_f32 v[84:85], v[54:55], v[54:55], v[84:85]
    s_nop 0
    v_pk_add_f32 v[82:83], v[82:83], v[84:85]
    v_add_f32 v80, v80, v81
    v_add_f32 v81, v82, v83
    v_mov_b32 v82, v80
    v_mov_b32 v83, v81
    s_nop 0
    v_permlane16_swap_b32 v80, v82
    v_permlane16_swap_b32 v81, v83
    v_pk_add_f32 v[80:81], v[80:81], v[82:83]
    s_nop 0
    v_mov_b32 v82, v80
    v_mov_b32 v83, v81
    s_nop 0
    v_permlane32_swap_b32 v80, v82
    v_permlane32_swap_b32 v81, v83
    v_pk_add_f32 v[80:81], v[80:81], v[82:83]
    ds_write_b64 v5, v[80:81] offset:1536
    s_waitcnt lgkmcnt(0)
    s_barrier
    ds_read_b64 v[80:81], v4 offset:1536
    ds_read_b64 v[82:83], v4 offset:2048
    ds_read_b64 v[84:85], v4 offset:2560
    buffer_load_dwordx4 v[124:127], v1, s[4:7], s40 offen offset:0
    buffer_load_dwordx4 v[128:131], v1, s[4:7], s40 offen offset:1024
    buffer_load_dwordx4 v[132:135], v1, s[4:7], s40 offen offset:2048
    s_add_u32 s40, s40, 3072
    s_waitcnt lgkmcnt(0)
    v_pk_add_f32 v[6:7], v[80:81], v[82:83]
    s_nop 0
    v_pk_add_f32 v[6:7], v[6:7], v[84:85]
    s_nop 0
    v_mul_f32 v6, 0x3ae38e39, v6
    v_mul_f32 v7, 0x3ae38e39, v7
    v_fma_f32 v7, -v6, v6, v7
    v_max_f32 v7, 0, v7
    v_cvt_pk_bf16_f32 v6, v6, v6
    v_and_b32 v6, 0xffff0000, v6
    v_cvt_pk_bf16_f32 v7, v7, v7
    v_and_b32 v7, 0xffff0000, v7
    v_add_f32 v7, 0x3727c5ac, v7
    v_cvt_pk_bf16_f32 v7, v7, v7
    v_and_b32 v7, 0xffff0000, v7
    v_sqrt_f32 v7, v7
    s_nop 0
    v_cvt_pk_bf16_f32 v7, v7, v7
    v_and_b32 v7, 0xffff0000, v7
    v_rcp_f32 v7, v7
    s_nop 0
    v_mul_f32 v86, v6, v7
    v_mov_b32 v6, v7
    v_pk_fma_f32 v[8:9], v[8:9], v[6:7], v[86:87] op_sel_hi:[1,0,0] neg_lo:[0,0,1] neg_hi:[0,0,1]
    v_pk_fma_f32 v[10:11], v[10:11], v[6:7], v[86:87] op_sel_hi:[1,0,0] neg_lo:[0,0,1] neg_hi:[0,0,1]
    v_pk_fma_f32 v[12:13], v[12:13], v[6:7], v[86:87] op_sel_hi:[1,0,0] neg_lo:[0,0,1] neg_hi:[0,0,1]
    v_pk_fma_f32 v[14:15], v[14:15], v[6:7], v[86:87] op_sel_hi:[1,0,0] neg_lo:[0,0,1] neg_hi:[0,0,1]
    v_cvt_pk_bf16_f32 v56, v8, v9
    v_cvt_pk_bf16_f32 v57, v10, v11
    v_cvt_pk_bf16_f32 v58, v12, v13
    v_cvt_pk_bf16_f32 v59, v14, v15
    ds_write_b128 v87, v[56:59] offset:0
    v_pk_fma_f32 v[16:17], v[16:17], v[6:7], v[86:87] op_sel_hi:[1,0,0] neg_lo:[0,0,1] neg_hi:[0,0,1]
    v_pk_fma_f32 v[18:19], v[18:19], v[6:7], v[86:87] op_sel_hi:[1,0,0] neg_lo:[0,0,1] neg_hi:[0,0,1]
    v_pk_fma_f32 v[20:21], v[20:21], v[6:7], v[86:87] op_sel_hi:[1,0,0] neg_lo:[0,0,1] neg_hi:[0,0,1]
    v_pk_fma_f32 v[22:23], v[22:23], v[6:7], v[86:87] op_sel_hi:[1,0,0] neg_lo:[0,0,1] neg_hi:[0,0,1]
    v_cvt_pk_bf16_f32 v60, v16, v17
    v_cvt_pk_bf16_f32 v61, v18, v19
    v_cvt_pk_bf16_f32 v62, v20, v21
    v_cvt_pk_bf16_f32 v63, v22, v23
    ds_write_b128 v87, v[60:63] offset:4096
    buffer_load_dwordx4 v[136:139], v1, s[4:7], s40 offen offset:0
    v_pk_fma_f32 v[24:25], v[24:25], v[6:7], v[86:87] op_sel_hi:[1,0,0] neg_lo:[0,0,1] neg_hi:[0,0,1]
    v_pk_fma_f32 v[26:27], v[26:27], v[6:7], v[86:87] op_sel_hi:[1,0,0] neg_lo:[0,0,1] neg_hi:[0,0,1]
    v_pk_fma_f32 v[28:29], v[28:29], v[6:7], v[86:87] op_sel_hi:[1,0,0] neg_lo:[0,0,1] neg_hi:[0,0,1]
    v_pk_fma_f32 v[30:31], v[30:31], v[6:7], v[86:87] op_sel_hi:[1,0,0] neg_lo:[0,0,1] neg_hi:[0,0,1]
    v_cvt_pk_bf16_f32 v56, v24, v25
    v_cvt_pk_bf16_f32 v57, v26, v27
    v_cvt_pk_bf16_f32 v58, v28, v29
    v_cvt_pk_bf16_f32 v59, v30, v31
    ds_write_b128 v87, v[56:59] offset:8192
    v_pk_fma_f32 v[32:33], v[32:33], v[6:7], v[86:87] op_sel_hi:[1,0,0] neg_lo:[0,0,1] neg_hi:[0,0,1]
    v_pk_fma_f32 v[34:35], v[34:35], v[6:7], v[86:87] op_sel_hi:[1,0,0] neg_lo:[0,0,1] neg_hi:[0,0,1]
    v_pk_fma_f32 v[36:37], v[36:37], v[6:7], v[86:87] op_sel_hi:[1,0,0] neg_lo:[0,0,1] neg_hi:[0,0,1]
    v_pk_fma_f32 v[38:39], v[38:39], v[6:7], v[86:87] op_sel_hi:[1,0,0] neg_lo:[0,0,1] neg_hi:[0,0,1]
    v_cvt_pk_bf16_f32 v60, v32, v33
    v_cvt_pk_bf16_f32 v61, v34, v35
    v_cvt_pk_bf16_f32 v62, v36, v37
    v_cvt_pk_bf16_f32 v63, v38, v39
    ds_write_b128 v87, v[60:63] offset:12288
    buffer_load_dwordx4 v[140:143], v1, s[4:7], s40 offen offset:1024
    v_pk_fma_f32 v[40:41], v[40:41], v[6:7], v[86:87] op_sel_hi:[1,0,0] neg_lo:[0,0,1] neg_hi:[0,0,1]
    v_pk_fma_f32 v[42:43], v[42:43], v[6:7], v[86:87] op_sel_hi:[1,0,0] neg_lo:[0,0,1] neg_hi:[0,0,1]
    v_pk_fma_f32 v[44:45], v[44:45], v[6:7], v[86:87] op_sel_hi:[1,0,0] neg_lo:[0,0,1] neg_hi:[0,0,1]
    v_pk_fma_f32 v[46:47], v[46:47], v[6:7], v[86:87] op_sel_hi:[1,0,0] neg_lo:[0,0,1] neg_hi:[0,0,1]
    v_cvt_pk_bf16_f32 v56, v40, v41
    v_cvt_pk_bf16_f32 v57, v42, v43
    v_cvt_pk_bf16_f32 v58, v44, v45
    v_cvt_pk_bf16_f32 v59, v46, v47
    ds_write_b128 v87, v[56:59] offset:16384
    v_pk_fma_f32 v[48:49], v[48:49], v[6:7], v[86:87] op_sel_hi:[1,0,0] neg_lo:[0,0,1] neg_hi:[0,0,1]
    v_pk_fma_f32 v[50:51], v[50:51], v[6:7], v[86:87] op_sel_hi:[1,0,0] neg_lo:[0,0,1] neg_hi:[0,0,1]
    v_pk_fma_f32 v[52:53], v[52:53], v[6:7], v[86:87] op_sel_hi:[1,0,0] neg_lo:[0,0,1] neg_hi:[0,0,1]
    v_pk_fma_f32 v[54:55], v[54:55], v[6:7], v[86:87] op_sel_hi:[1,0,0] neg_lo:[0,0,1] neg_hi:[0,0,1]
    v_cvt_pk_bf16_f32 v60, v48, v49
    v_cvt_pk_bf16_f32 v61, v50, v51
    v_cvt_pk_bf16_f32 v62, v52, v53
    v_cvt_pk_bf16_f32 v63, v54, v55
    ds_write_b128 v87, v[60:63] offset:20480
    buffer_load_dwordx4 v[144:147], v1, s[4:7], s40 offen offset:2048
    s_add_u32 s40, s40, 3072
    s_waitcnt vmcnt(15)
    v_lshlrev_b32 v148, 16, v150
    v_and_b32 v149, 0xffff0000, v150
    v_lshlrev_b32 v150, 16, v151
    v_and_b32 v151, 0xffff0000, v151
    v_lshlrev_b32 v152, 16, v154
    v_and_b32 v153, 0xffff0000, v154
    v_lshlrev_b32 v154, 16, v155
    v_and_b32 v155, 0xffff0000, v155
    v_lshlrev_b32 v156, 16, v158
    v_and_b32 v157, 0xffff0000, v158
    v_lshlrev_b32 v158, 16, v159
    v_and_b32 v159, 0xffff0000, v159
    v_add_u32 v4, 73728, v1
    v_add_u32 v5, 139264, v1
    v_mov_b32 v6, 155648
    v_mov_b32 v7, 1
    v_add_u32 v3, 65536, v1
    s_waitcnt lgkmcnt(0)
    s_barrier
    ds_read_b128 v[56:59], v1 offset:0
    ds_read_b128 v[60:63], v1 offset:1024
    ds_read_b128 v[64:67], v1 offset:2048
    ds_read_b128 v[68:71], v1 offset:3072
    s_waitcnt vmcnt(12) lgkmcnt(0)
    v_mfma_f32_16x16x32_bf16 v[8:11], v[88:91], v[56:59], v[148:151]
    ds_read_b128 v[72:75], v1 offset:4096
    v_mfma_f32_16x16x32_bf16 v[12:15], v[88:91], v[60:63], v[148:151]
    v_mfma_f32_16x16x32_bf16 v[16:19], v[88:91], v[64:67], v[148:151]
    ds_read_b128 v[76:79], v1 offset:5120
    v_mfma_f32_16x16x32_bf16 v[20:23], v[88:91], v[68:71], v[148:151]
    buffer_load_dwordx4 v[88:91], v1, s[4:7], s40 offen offset:0
    v_mfma_f32_16x16x32_bf16 v[24:27], v[92:95], v[56:59], v[152:155]
    ds_read_b128 v[80:83], v1 offset:6144
    v_mfma_f32_16x16x32_bf16 v[28:31], v[92:95], v[60:63], v[152:155]
    v_mfma_f32_16x16x32_bf16 v[32:35], v[92:95], v[64:67], v[152:155]
    ds_read_b128 v[84:87], v1 offset:7168
    v_mfma_f32_16x16x32_bf16 v[36:39], v[92:95], v[68:71], v[152:155]
    buffer_load_dwordx4 v[92:95], v1, s[4:7], s40 offen offset:1024
    v_mfma_f32_16x16x32_bf16 v[40:43], v[96:99], v[56:59], v[156:159]
    v_mfma_f32_16x16x32_bf16 v[44:47], v[96:99], v[60:63], v[156:159]
    v_mfma_f32_16x16x32_bf16 v[48:51], v[96:99], v[64:67], v[156:159]
    v_mfma_f32_16x16x32_bf16 v[52:55], v[96:99], v[68:71], v[156:159]
    buffer_load_dwordx4 v[96:99], v1, s[4:7], s40 offen offset:2048
    s_add_u32 s40, s40, 3072
    s_waitcnt vmcnt(12) lgkmcnt(0)
    v_mfma_f32_16x16x32_bf16 v[8:11], v[100:103], v[72:75], v[8:11]
    ds_read_b128 v[56:59], v1 offset:8192
    v_mfma_f32_16x16x32_bf16 v[12:15], v[100:103], v[76:79], v[12:15]
    v_mfma_f32_16x16x32_bf16 v[16:19], v[100:103], v[80:83], v[16:19]
    ds_read_b128 v[60:63], v1 offset:9216
    v_mfma_f32_16x16x32_bf16 v[20:23], v[100:103], v[84:87], v[20:23]
    buffer_load_dwordx4 v[100:103], v1, s[4:7], s40 offen offset:0
    v_mfma_f32_16x16x32_bf16 v[24:27], v[104:107], v[72:75], v[24:27]
    ds_read_b128 v[64:67], v1 offset:10240
    v_mfma_f32_16x16x32_bf16 v[28:31], v[104:107], v[76:79], v[28:31]
    v_mfma_f32_16x16x32_bf16 v[32:35], v[104:107], v[80:83], v[32:35]
    ds_read_b128 v[68:71], v1 offset:11264
    v_mfma_f32_16x16x32_bf16 v[36:39], v[104:107], v[84:87], v[36:39]
    buffer_load_dwordx4 v[104:107], v1, s[4:7], s40 offen offset:1024
    v_mfma_f32_16x16x32_bf16 v[40:43], v[108:111], v[72:75], v[40:43]
    v_mfma_f32_16x16x32_bf16 v[44:47], v[108:111], v[76:79], v[44:47]
    v_mfma_f32_16x16x32_bf16 v[48:51], v[108:111], v[80:83], v[48:51]
    v_mfma_f32_16x16x32_bf16 v[52:55], v[108:111], v[84:87], v[52:55]
    buffer_load_dwordx4 v[108:111], v1, s[4:7], s40 offen offset:2048
    s_add_u32 s40, s40, 3072
    s_waitcnt vmcnt(12) lgkmcnt(0)
    v_mfma_f32_16x16x32_bf16 v[8:11], v[112:115], v[56:59], v[8:11]
    ds_read_b128 v[72:75], v1 offset:12288
    v_mfma_f32_16x16x32_bf16 v[12:15], v[112:115], v[60:63], v[12:15]
    v_mfma_f32_16x16x32_bf16 v[16:19], v[112:115], v[64:67], v[16:19]
    ds_read_b128 v[76:79], v1 offset:13312
    v_mfma_f32_16x16x32_bf16 v[20:23], v[112:115], v[68:71], v[20:23]
    buffer_load_dwordx4 v[112:115], v1, s[4:7], s40 offen offset:0
    v_mfma_f32_16x16x32_bf16 v[24:27], v[116:119], v[56:59], v[24:27]
    ds_read_b128 v[80:83], v1 offset:14336
    v_mfma_f32_16x16x32_bf16 v[28:31], v[116:119], v[60:63], v[28:31]
    v_mfma_f32_16x16x32_bf16 v[32:35], v[116:119], v[64:67], v[32:35]
    ds_read_b128 v[84:87], v1 offset:15360
    v_mfma_f32_16x16x32_bf16 v[36:39], v[116:119], v[68:71], v[36:39]
    buffer_load_dwordx4 v[116:119], v1, s[4:7], s40 offen offset:1024
    v_mfma_f32_16x16x32_bf16 v[40:43], v[120:123], v[56:59], v[40:43]
    v_mfma_f32_16x16x32_bf16 v[44:47], v[120:123], v[60:63], v[44:47]
    v_mfma_f32_16x16x32_bf16 v[48:51], v[120:123], v[64:67], v[48:51]
    v_mfma_f32_16x16x32_bf16 v[52:55], v[120:123], v[68:71], v[52:55]
    buffer_load_dwordx4 v[120:123], v1, s[4:7], s40 offen offset:2048
    s_add_u32 s40, s40, 3072
    s_waitcnt vmcnt(12) lgkmcnt(0)
    v_mfma_f32_16x16x32_bf16 v[8:11], v[124:127], v[72:75], v[8:11]
    ds_read_b128 v[56:59], v1 offset:16384
    v_mfma_f32_16x16x32_bf16 v[12:15], v[124:127], v[76:79], v[12:15]
    v_mfma_f32_16x16x32_bf16 v[16:19], v[124:127], v[80:83], v[16:19]
    ds_read_b128 v[60:63], v1 offset:17408
    v_mfma_f32_16x16x32_bf16 v[20:23], v[124:127], v[84:87], v[20:23]
    buffer_load_dwordx4 v[124:127], v1, s[4:7], s40 offen offset:0
    v_mfma_f32_16x16x32_bf16 v[24:27], v[128:131], v[72:75], v[24:27]
    ds_read_b128 v[64:67], v1 offset:18432
    v_mfma_f32_16x16x32_bf16 v[28:31], v[128:131], v[76:79], v[28:31]
    v_mfma_f32_16x16x32_bf16 v[32:35], v[128:131], v[80:83], v[32:35]
    ds_read_b128 v[68:71], v1 offset:19456
    v_mfma_f32_16x16x32_bf16 v[36:39], v[128:131], v[84:87], v[36:39]
    buffer_load_dwordx4 v[128:131], v1, s[4:7], s40 offen offset:1024
    v_mfma_f32_16x16x32_bf16 v[40:43], v[132:135], v[72:75], v[40:43]
    v_mfma_f32_16x16x32_bf16 v[44:47], v[132:135], v[76:79], v[44:47]
    v_mfma_f32_16x16x32_bf16 v[48:51], v[132:135], v[80:83], v[48:51]
    v_mfma_f32_16x16x32_bf16 v[52:55], v[132:135], v[84:87], v[52:55]
    buffer_load_dwordx4 v[132:135], v1, s[4:7], s40 offen offset:2048
    s_add_u32 s40, s40, 3072
    s_waitcnt vmcnt(12) lgkmcnt(0)
    v_mfma_f32_16x16x32_bf16 v[8:11], v[136:139], v[56:59], v[8:11]
    ds_read_b128 v[72:75], v1 offset:20480
    v_mfma_f32_16x16x32_bf16 v[12:15], v[136:139], v[60:63], v[12:15]
    v_mfma_f32_16x16x32_bf16 v[16:19], v[136:139], v[64:67], v[16:19]
    ds_read_b128 v[76:79], v1 offset:21504
    v_mfma_f32_16x16x32_bf16 v[20:23], v[136:139], v[68:71], v[20:23]
    buffer_load_dwordx4 v[136:139], v1, s[4:7], s40 offen offset:0
    v_mfma_f32_16x16x32_bf16 v[24:27], v[140:143], v[56:59], v[24:27]
    ds_read_b128 v[80:83], v1 offset:22528
    v_mfma_f32_16x16x32_bf16 v[28:31], v[140:143], v[60:63], v[28:31]
    v_mfma_f32_16x16x32_bf16 v[32:35], v[140:143], v[64:67], v[32:35]
    ds_read_b128 v[84:87], v1 offset:23552
    v_mfma_f32_16x16x32_bf16 v[36:39], v[140:143], v[68:71], v[36:39]
    buffer_load_dwordx4 v[140:143], v1, s[4:7], s40 offen offset:1024
    v_mfma_f32_16x16x32_bf16 v[40:43], v[144:147], v[56:59], v[40:43]
    v_mfma_f32_16x16x32_bf16 v[44:47], v[144:147], v[60:63], v[44:47]
    v_mfma_f32_16x16x32_bf16 v[48:51], v[144:147], v[64:67], v[48:51]
    v_mfma_f32_16x16x32_bf16 v[52:55], v[144:147], v[68:71], v[52:55]
    buffer_load_dwordx4 v[144:147], v1, s[4:7], s40 offen offset:2048
    s_add_u32 s40, s40, 3072
    s_waitcnt vmcnt(12) lgkmcnt(0)
    v_mfma_f32_16x16x32_bf16 v[8:11], v[88:91], v[72:75], v[8:11]
    ds_read_b128 v[56:59], v1 offset:24576
    v_mfma_f32_16x16x32_bf16 v[12:15], v[88:91], v[76:79], v[12:15]
    v_mfma_f32_16x16x32_bf16 v[16:19], v[88:91], v[80:83], v[16:19]
    ds_read_b128 v[60:63], v1 offset:25600
    v_mfma_f32_16x16x32_bf16 v[20:23], v[88:91], v[84:87], v[20:23]
    buffer_load_dwordx4 v[88:91], v1, s[4:7], s40 offen offset:0
    v_mfma_f32_16x16x32_bf16 v[24:27], v[92:95], v[72:75], v[24:27]
    ds_read_b128 v[64:67], v1 offset:26624
    v_mfma_f32_16x16x32_bf16 v[28:31], v[92:95], v[76:79], v[28:31]
    v_mfma_f32_16x16x32_bf16 v[32:35], v[92:95], v[80:83], v[32:35]
    ds_read_b128 v[68:71], v1 offset:27648
    v_mfma_f32_16x16x32_bf16 v[36:39], v[92:95], v[84:87], v[36:39]
    buffer_load_dwordx4 v[92:95], v1, s[4:7], s40 offen offset:1024
    v_mfma_f32_16x16x32_bf16 v[40:43], v[96:99], v[72:75], v[40:43]
    v_mfma_f32_16x16x32_bf16 v[44:47], v[96:99], v[76:79], v[44:47]
    v_mfma_f32_16x16x32_bf16 v[48:51], v[96:99], v[80:83], v[48:51]
    v_mfma_f32_16x16x32_bf16 v[52:55], v[96:99], v[84:87], v[52:55]
    buffer_load_dwordx4 v[96:99], v1, s[4:7], s40 offen offset:2048
    s_add_u32 s40, s40, 3072
    s_waitcnt vmcnt(12) lgkmcnt(0)
    v_mfma_f32_16x16x32_bf16 v[8:11], v[100:103], v[56:59], v[8:11]
    ds_read_b128 v[72:75], v1 offset:28672
    v_mfma_f32_16x16x32_bf16 v[12:15], v[100:103], v[60:63], v[12:15]
    v_mfma_f32_16x16x32_bf16 v[16:19], v[100:103], v[64:67], v[16:19]
    ds_read_b128 v[76:79], v1 offset:29696
    v_mfma_f32_16x16x32_bf16 v[20:23], v[100:103], v[68:71], v[20:23]
    buffer_load_dwordx4 v[100:103], v1, s[4:7], s40 offen offset:0
    v_mfma_f32_16x16x32_bf16 v[24:27], v[104:107], v[56:59], v[24:27]
    ds_read_b128 v[80:83], v1 offset:30720
    v_mfma_f32_16x16x32_bf16 v[28:31], v[104:107], v[60:63], v[28:31]
    v_mfma_f32_16x16x32_bf16 v[32:35], v[104:107], v[64:67], v[32:35]
    ds_read_b128 v[84:87], v1 offset:31744
    v_mfma_f32_16x16x32_bf16 v[36:39], v[104:107], v[68:71], v[36:39]
    buffer_load_dwordx4 v[104:107], v1, s[4:7], s40 offen offset:1024
    v_mfma_f32_16x16x32_bf16 v[40:43], v[108:111], v[56:59], v[40:43]
    v_mfma_f32_16x16x32_bf16 v[44:47], v[108:111], v[60:63], v[44:47]
    v_mfma_f32_16x16x32_bf16 v[48:51], v[108:111], v[64:67], v[48:51]
    v_mfma_f32_16x16x32_bf16 v[52:55], v[108:111], v[68:71], v[52:55]
    buffer_load_dwordx4 v[108:111], v1, s[4:7], s40 offen offset:2048
    s_add_u32 s40, s40, 3072
    s_waitcnt vmcnt(12) lgkmcnt(0)
    v_mfma_f32_16x16x32_bf16 v[8:11], v[112:115], v[72:75], v[8:11]
    ds_read_b128 v[56:59], v1 offset:32768
    v_mfma_f32_16x16x32_bf16 v[12:15], v[112:115], v[76:79], v[12:15]
    v_mfma_f32_16x16x32_bf16 v[16:19], v[112:115], v[80:83], v[16:19]
    ds_read_b128 v[60:63], v1 offset:33792
    v_mfma_f32_16x16x32_bf16 v[20:23], v[112:115], v[84:87], v[20:23]
    buffer_load_dwordx4 v[112:115], v1, s[4:7], s40 offen offset:0
    v_mfma_f32_16x16x32_bf16 v[24:27], v[116:119], v[72:75], v[24:27]
    ds_read_b128 v[64:67], v1 offset:34816
    v_mfma_f32_16x16x32_bf16 v[28:31], v[116:119], v[76:79], v[28:31]
    v_mfma_f32_16x16x32_bf16 v[32:35], v[116:119], v[80:83], v[32:35]
    ds_read_b128 v[68:71], v1 offset:35840
    v_mfma_f32_16x16x32_bf16 v[36:39], v[116:119], v[84:87], v[36:39]
    buffer_load_dwordx4 v[116:119], v1, s[4:7], s40 offen offset:1024
    v_mfma_f32_16x16x32_bf16 v[40:43], v[120:123], v[72:75], v[40:43]
    v_mfma_f32_16x16x32_bf16 v[44:47], v[120:123], v[76:79], v[44:47]
    v_mfma_f32_16x16x32_bf16 v[48:51], v[120:123], v[80:83], v[48:51]
    v_mfma_f32_16x16x32_bf16 v[52:55], v[120:123], v[84:87], v[52:55]
    buffer_load_dwordx4 v[120:123], v1, s[4:7], s40 offen offset:2048
    s_add_u32 s40, s40, 3072
    s_waitcnt vmcnt(12) lgkmcnt(0)
    v_mfma_f32_16x16x32_bf16 v[8:11], v[124:127], v[56:59], v[8:11]
    ds_read_b128 v[72:75], v1 offset:36864
    v_mfma_f32_16x16x32_bf16 v[12:15], v[124:127], v[60:63], v[12:15]
    v_mfma_f32_16x16x32_bf16 v[16:19], v[124:127], v[64:67], v[16:19]
    ds_read_b128 v[76:79], v1 offset:37888
    v_mfma_f32_16x16x32_bf16 v[20:23], v[124:127], v[68:71], v[20:23]
    buffer_load_dwordx4 v[124:127], v1, s[4:7], s40 offen offset:0
    v_mfma_f32_16x16x32_bf16 v[24:27], v[128:131], v[56:59], v[24:27]
    ds_read_b128 v[80:83], v1 offset:38912
    v_mfma_f32_16x16x32_bf16 v[28:31], v[128:131], v[60:63], v[28:31]
    v_mfma_f32_16x16x32_bf16 v[32:35], v[128:131], v[64:67], v[32:35]
    ds_read_b128 v[84:87], v1 offset:39936
    v_mfma_f32_16x16x32_bf16 v[36:39], v[128:131], v[68:71], v[36:39]
    buffer_load_dwordx4 v[128:131], v1, s[4:7], s40 offen offset:1024
    v_mfma_f32_16x16x32_bf16 v[40:43], v[132:135], v[56:59], v[40:43]
    v_mfma_f32_16x16x32_bf16 v[44:47], v[132:135], v[60:63], v[44:47]
    v_mfma_f32_16x16x32_bf16 v[48:51], v[132:135], v[64:67], v[48:51]
    v_mfma_f32_16x16x32_bf16 v[52:55], v[132:135], v[68:71], v[52:55]
    buffer_load_dwordx4 v[132:135], v1, s[4:7], s40 offen offset:2048
    s_add_u32 s40, s40, 3072
    s_waitcnt vmcnt(12) lgkmcnt(0)
    v_mfma_f32_16x16x32_bf16 v[8:11], v[136:139], v[72:75], v[8:11]
    ds_read_b128 v[56:59], v1 offset:40960
    v_mfma_f32_16x16x32_bf16 v[12:15], v[136:139], v[76:79], v[12:15]
    v_mfma_f32_16x16x32_bf16 v[16:19], v[136:139], v[80:83], v[16:19]
    ds_read_b128 v[60:63], v1 offset:41984
    v_mfma_f32_16x16x32_bf16 v[20:23], v[136:139], v[84:87], v[20:23]
    buffer_load_dwordx4 v[136:139], v1, s[4:7], s40 offen offset:0
    v_mfma_f32_16x16x32_bf16 v[24:27], v[140:143], v[72:75], v[24:27]
    ds_read_b128 v[64:67], v1 offset:43008
    v_mfma_f32_16x16x32_bf16 v[28:31], v[140:143], v[76:79], v[28:31]
    v_mfma_f32_16x16x32_bf16 v[32:35], v[140:143], v[80:83], v[32:35]
    ds_read_b128 v[68:71], v1 offset:44032
    v_mfma_f32_16x16x32_bf16 v[36:39], v[140:143], v[84:87], v[36:39]
    buffer_load_dwordx4 v[140:143], v1, s[4:7], s40 offen offset:1024
    v_mfma_f32_16x16x32_bf16 v[40:43], v[144:147], v[72:75], v[40:43]
    v_mfma_f32_16x16x32_bf16 v[44:47], v[144:147], v[76:79], v[44:47]
    v_mfma_f32_16x16x32_bf16 v[48:51], v[144:147], v[80:83], v[48:51]
    v_mfma_f32_16x16x32_bf16 v[52:55], v[144:147], v[84:87], v[52:55]
    buffer_load_dwordx4 v[144:147], v1, s[4:7], s40 offen offset:2048
    s_add_u32 s40, s40, 3072
    s_waitcnt vmcnt(12) lgkmcnt(0)
    v_mfma_f32_16x16x32_bf16 v[8:11], v[88:91], v[56:59], v[8:11]
    ds_read_b128 v[72:75], v1 offset:45056
    v_mfma_f32_16x16x32_bf16 v[12:15], v[88:91], v[60:63], v[12:15]
    v_mfma_f32_16x16x32_bf16 v[16:19], v[88:91], v[64:67], v[16:19]
    ds_read_b128 v[76:79], v1 offset:46080
    v_mfma_f32_16x16x32_bf16 v[20:23], v[88:91], v[68:71], v[20:23]
    buffer_load_dwordx4 v[88:91], v1, s[4:7], s40 offen offset:0
    v_mfma_f32_16x16x32_bf16 v[24:27], v[92:95], v[56:59], v[24:27]
    ds_read_b128 v[80:83], v1 offset:47104
    v_mfma_f32_16x16x32_bf16 v[28:31], v[92:95], v[60:63], v[28:31]
    v_mfma_f32_16x16x32_bf16 v[32:35], v[92:95], v[64:67], v[32:35]
    ds_read_b128 v[84:87], v1 offset:48128
    v_mfma_f32_16x16x32_bf16 v[36:39], v[92:95], v[68:71], v[36:39]
    buffer_load_dwordx4 v[92:95], v1, s[4:7], s40 offen offset:1024
    v_mfma_f32_16x16x32_bf16 v[40:43], v[96:99], v[56:59], v[40:43]
    v_mfma_f32_16x16x32_bf16 v[44:47], v[96:99], v[60:63], v[44:47]
    v_mfma_f32_16x16x32_bf16 v[48:51], v[96:99], v[64:67], v[48:51]
    v_mfma_f32_16x16x32_bf16 v[52:55], v[96:99], v[68:71], v[52:55]
    buffer_load_dwordx4 v[96:99], v1, s[4:7], s40 offen offset:2048
    s_add_u32 s40, s40, 3072
    s_waitcnt vmcnt(12) lgkmcnt(0)
    v_mfma_f32_16x16x32_bf16 v[8:11], v[100:103], v[72:75], v[8:11]
    ds_read_b128 v[56:59], v1 offset:49152
    v_mfma_f32_16x16x32_bf16 v[12:15], v[100:103], v[76:79], v[12:15]
    v_mfma_f32_16x16x32_bf16 v[16:19], v[100:103], v[80:83], v[16:19]
    ds_read_b128 v[60:63], v1 offset:50176
    v_mfma_f32_16x16x32_bf16 v[20:23], v[100:103], v[84:87], v[20:23]
    buffer_load_dwordx4 v[100:103], v1, s[4:7], s40 offen offset:0
    v_mfma_f32_16x16x32_bf16 v[24:27], v[104:107], v[72:75], v[24:27]
    ds_read_b128 v[64:67], v1 offset:51200
    v_mfma_f32_16x16x32_bf16 v[28:31], v[104:107], v[76:79], v[28:31]
    v_mfma_f32_16x16x32_bf16 v[32:35], v[104:107], v[80:83], v[32:35]
    ds_read_b128 v[68:71], v1 offset:52224
    v_mfma_f32_16x16x32_bf16 v[36:39], v[104:107], v[84:87], v[36:39]
    buffer_load_dwordx4 v[104:107], v1, s[4:7], s40 offen offset:1024
    v_mfma_f32_16x16x32_bf16 v[40:43], v[108:111], v[72:75], v[40:43]
    v_mfma_f32_16x16x32_bf16 v[44:47], v[108:111], v[76:79], v[44:47]
    v_mfma_f32_16x16x32_bf16 v[48:51], v[108:111], v[80:83], v[48:51]
    v_mfma_f32_16x16x32_bf16 v[52:55], v[108:111], v[84:87], v[52:55]
    buffer_load_dwordx4 v[108:111], v1, s[4:7], s40 offen offset:2048
    s_add_u32 s40, s40, 3072
    s_waitcnt vmcnt(12) lgkmcnt(0)
    v_mfma_f32_16x16x32_bf16 v[8:11], v[112:115], v[56:59], v[8:11]
    ds_read_b128 v[72:75], v1 offset:53248
    v_mfma_f32_16x16x32_bf16 v[12:15], v[112:115], v[60:63], v[12:15]
    v_mfma_f32_16x16x32_bf16 v[16:19], v[112:115], v[64:67], v[16:19]
    ds_read_b128 v[76:79], v1 offset:54272
    v_mfma_f32_16x16x32_bf16 v[20:23], v[112:115], v[68:71], v[20:23]
    buffer_load_dwordx4 v[112:115], v1, s[4:7], s40 offen offset:0
    v_mfma_f32_16x16x32_bf16 v[24:27], v[116:119], v[56:59], v[24:27]
    ds_read_b128 v[80:83], v1 offset:55296
    v_mfma_f32_16x16x32_bf16 v[28:31], v[116:119], v[60:63], v[28:31]
    v_mfma_f32_16x16x32_bf16 v[32:35], v[116:119], v[64:67], v[32:35]
    ds_read_b128 v[84:87], v1 offset:56320
    v_mfma_f32_16x16x32_bf16 v[36:39], v[116:119], v[68:71], v[36:39]
    buffer_load_dwordx4 v[116:119], v1, s[4:7], s40 offen offset:1024
    v_mfma_f32_16x16x32_bf16 v[40:43], v[120:123], v[56:59], v[40:43]
    v_mfma_f32_16x16x32_bf16 v[44:47], v[120:123], v[60:63], v[44:47]
    v_mfma_f32_16x16x32_bf16 v[48:51], v[120:123], v[64:67], v[48:51]
    v_mfma_f32_16x16x32_bf16 v[52:55], v[120:123], v[68:71], v[52:55]
    buffer_load_dwordx4 v[120:123], v1, s[4:7], s40 offen offset:2048
    s_mov_b32 s40, s41
    s_waitcnt vmcnt(12) lgkmcnt(0)
    v_mfma_f32_16x16x32_bf16 v[8:11], v[124:127], v[72:75], v[8:11]
    ds_read_b128 v[56:59], v1 offset:57344
    v_mfma_f32_16x16x32_bf16 v[12:15], v[124:127], v[76:79], v[12:15]
    v_mfma_f32_16x16x32_bf16 v[16:19], v[124:127], v[80:83], v[16:19]
    ds_read_b128 v[60:63], v1 offset:58368
    v_mfma_f32_16x16x32_bf16 v[20:23], v[124:127], v[84:87], v[20:23]
    buffer_load_dwordx4 v[124:127], v1, s[4:7], s40 offen offset:0
    v_mfma_f32_16x16x32_bf16 v[24:27], v[128:131], v[72:75], v[24:27]
    ds_read_b128 v[64:67], v1 offset:59392
    v_mfma_f32_16x16x32_bf16 v[28:31], v[128:131], v[76:79], v[28:31]
    v_mfma_f32_16x16x32_bf16 v[32:35], v[128:131], v[80:83], v[32:35]
    ds_read_b128 v[68:71], v1 offset:60416
    v_mfma_f32_16x16x32_bf16 v[36:39], v[128:131], v[84:87], v[36:39]
    buffer_load_dwordx4 v[128:131], v1, s[4:7], s40 offen offset:1024
    v_mfma_f32_16x16x32_bf16 v[40:43], v[132:135], v[72:75], v[40:43]
    v_mfma_f32_16x16x32_bf16 v[44:47], v[132:135], v[76:79], v[44:47]
    v_mfma_f32_16x16x32_bf16 v[48:51], v[132:135], v[80:83], v[48:51]
    v_mfma_f32_16x16x32_bf16 v[52:55], v[132:135], v[84:87], v[52:55]
    buffer_load_dwordx4 v[132:135], v1, s[4:7], s40 offen offset:2048
    s_add_u32 s40, s40, 3072
    s_waitcnt vmcnt(12) lgkmcnt(0)
    v_mfma_f32_16x16x32_bf16 v[8:11], v[136:139], v[56:59], v[8:11]
    ds_read_b128 v[72:75], v1 offset:61440
    v_mfma_f32_16x16x32_bf16 v[12:15], v[136:139], v[60:63], v[12:15]
    v_mfma_f32_16x16x32_bf16 v[16:19], v[136:139], v[64:67], v[16:19]
    ds_read_b128 v[76:79], v1 offset:62464
    v_mfma_f32_16x16x32_bf16 v[20:23], v[136:139], v[68:71], v[20:23]
    buffer_load_dwordx4 v[136:139], v1, s[4:7], s40 offen offset:0
    v_mfma_f32_16x16x32_bf16 v[24:27], v[140:143], v[56:59], v[24:27]
    ds_read_b128 v[80:83], v1 offset:63488
    v_mfma_f32_16x16x32_bf16 v[28:31], v[140:143], v[60:63], v[28:31]
    v_mfma_f32_16x16x32_bf16 v[32:35], v[140:143], v[64:67], v[32:35]
    ds_read_b128 v[84:87], v1 offset:64512
    v_mfma_f32_16x16x32_bf16 v[36:39], v[140:143], v[68:71], v[36:39]
    buffer_load_dwordx4 v[140:143], v1, s[4:7], s40 offen offset:1024
    v_mfma_f32_16x16x32_bf16 v[40:43], v[144:147], v[56:59], v[40:43]
    v_mfma_f32_16x16x32_bf16 v[44:47], v[144:147], v[60:63], v[44:47]
    v_mfma_f32_16x16x32_bf16 v[48:51], v[144:147], v[64:67], v[48:51]
    v_mfma_f32_16x16x32_bf16 v[52:55], v[144:147], v[68:71], v[52:55]
    buffer_load_dwordx4 v[144:147], v1, s[4:7], s40 offen offset:2048
    s_add_u32 s40, s40, 3072
    s_waitcnt vmcnt(12) lgkmcnt(0)
    v_mfma_f32_16x16x32_bf16 v[8:11], v[88:91], v[72:75], v[8:11]
    ds_read_b128 v[56:59], v3 offset:0
    v_mfma_f32_16x16x32_bf16 v[12:15], v[88:91], v[76:79], v[12:15]
    v_mfma_f32_16x16x32_bf16 v[16:19], v[88:91], v[80:83], v[16:19]
    ds_read_b128 v[60:63], v3 offset:1024
    v_mfma_f32_16x16x32_bf16 v[20:23], v[88:91], v[84:87], v[20:23]
    buffer_load_dwordx4 v[88:91], v1, s[4:7], s40 offen offset:0
    v_mfma_f32_16x16x32_bf16 v[24:27], v[92:95], v[72:75], v[24:27]
    ds_read_b128 v[64:67], v3 offset:2048
    v_mfma_f32_16x16x32_bf16 v[28:31], v[92:95], v[76:79], v[28:31]
    v_mfma_f32_16x16x32_bf16 v[32:35], v[92:95], v[80:83], v[32:35]
    ds_read_b128 v[68:71], v3 offset:3072
    v_mfma_f32_16x16x32_bf16 v[36:39], v[92:95], v[84:87], v[36:39]
    buffer_load_dwordx4 v[92:95], v1, s[4:7], s40 offen offset:1024
    v_mfma_f32_16x16x32_bf16 v[40:43], v[96:99], v[72:75], v[40:43]
    v_mfma_f32_16x16x32_bf16 v[44:47], v[96:99], v[76:79], v[44:47]
    v_mfma_f32_16x16x32_bf16 v[48:51], v[96:99], v[80:83], v[48:51]
    v_mfma_f32_16x16x32_bf16 v[52:55], v[96:99], v[84:87], v[52:55]
    buffer_load_dwordx4 v[96:99], v1, s[4:7], s40 offen offset:2048
    s_add_u32 s40, s40, 3072
    s_waitcnt vmcnt(12) lgkmcnt(0)
    v_mfma_f32_16x16x32_bf16 v[8:11], v[100:103], v[56:59], v[8:11]
    ds_read_b128 v[72:75], v3 offset:4096
    v_mfma_f32_16x16x32_bf16 v[12:15], v[100:103], v[60:63], v[12:15]
    v_mfma_f32_16x16x32_bf16 v[16:19], v[100:103], v[64:67], v[16:19]
    ds_read_b128 v[76:79], v3 offset:5120
    v_mfma_f32_16x16x32_bf16 v[20:23], v[100:103], v[68:71], v[20:23]
    buffer_load_dwordx4 v[100:103], v1, s[4:7], s40 offen offset:0
    v_mfma_f32_16x16x32_bf16 v[24:27], v[104:107], v[56:59], v[24:27]
    ds_read_b128 v[80:83], v3 offset:6144
    v_mfma_f32_16x16x32_bf16 v[28:31], v[104:107], v[60:63], v[28:31]
    v_mfma_f32_16x16x32_bf16 v[32:35], v[104:107], v[64:67], v[32:35]
    ds_read_b128 v[84:87], v3 offset:7168
    v_mfma_f32_16x16x32_bf16 v[36:39], v[104:107], v[68:71], v[36:39]
    buffer_load_dwordx4 v[104:107], v1, s[4:7], s40 offen offset:1024
    v_mfma_f32_16x16x32_bf16 v[40:43], v[108:111], v[56:59], v[40:43]
    v_mfma_f32_16x16x32_bf16 v[44:47], v[108:111], v[60:63], v[44:47]
    v_mfma_f32_16x16x32_bf16 v[48:51], v[108:111], v[64:67], v[48:51]
    v_mfma_f32_16x16x32_bf16 v[52:55], v[108:111], v[68:71], v[52:55]
    buffer_load_dwordx4 v[108:111], v1, s[4:7], s40 offen offset:2048
    s_add_u32 s40, s40, 3072
    s_waitcnt vmcnt(12) lgkmcnt(0)
    v_mfma_f32_16x16x32_bf16 v[8:11], v[112:115], v[72:75], v[8:11]
    v_mfma_f32_16x16x32_bf16 v[12:15], v[112:115], v[76:79], v[12:15]
    v_mfma_f32_16x16x32_bf16 v[16:19], v[112:115], v[80:83], v[16:19]
    v_mfma_f32_16x16x32_bf16 v[20:23], v[112:115], v[84:87], v[20:23]
    buffer_load_dwordx4 v[112:115], v1, s[4:7], s40 offen offset:0
    v_mfma_f32_16x16x32_bf16 v[24:27], v[116:119], v[72:75], v[24:27]
    v_mfma_f32_16x16x32_bf16 v[28:31], v[116:119], v[76:79], v[28:31]
    v_mfma_f32_16x16x32_bf16 v[32:35], v[116:119], v[80:83], v[32:35]
    v_mfma_f32_16x16x32_bf16 v[36:39], v[116:119], v[84:87], v[36:39]
    buffer_load_dwordx4 v[116:119], v1, s[4:7], s40 offen offset:1024
    v_mfma_f32_16x16x32_bf16 v[40:43], v[120:123], v[72:75], v[40:43]
    v_mfma_f32_16x16x32_bf16 v[44:47], v[120:123], v[76:79], v[44:47]
    v_mfma_f32_16x16x32_bf16 v[48:51], v[120:123], v[80:83], v[48:51]
    v_mfma_f32_16x16x32_bf16 v[52:55], v[120:123], v[84:87], v[52:55]
    buffer_load_dwordx4 v[120:123], v1, s[4:7], s40 offen offset:2048
    s_add_u32 s40, s40, 3072
    s_setprio 0
    v_mov_b32 v160, 0xbdd2d3e8
    v_mul_f32 v80, v8, v8
    v_mul_f32 v81, v9, v9
    v_mul_f32 v82, v10, v10
    v_mul_f32 v83, v11, v11
    v_mul_f32 v84, v24, v24
    v_mul_f32 v85, v25, v25
    v_mul_f32 v86, v26, v26
    v_mul_f32 v87, v27, v27
    v_fmaak_f32 v80, v80, v160, 0xc0135761
    v_fmaak_f32 v81, v81, v160, 0xc0135761
    v_fmaak_f32 v82, v82, v160, 0xc0135761
    v_fmaak_f32 v83, v83, v160, 0xc0135761
    v_fmaak_f32 v84, v84, v160, 0xc0135761
    v_fmaak_f32 v85, v85, v160, 0xc0135761
    v_fmaak_f32 v86, v86, v160, 0xc0135761
    v_fmaak_f32 v87, v87, v160, 0xc0135761
    v_mul_f32 v80, v80, v8
    v_mul_f32 v81, v81, v9
    v_mul_f32 v82, v82, v10
    v_mul_f32 v83, v83, v11
    v_mul_f32 v84, v84, v24
    v_mul_f32 v85, v85, v25
    v_mul_f32 v86, v86, v26
    v_mul_f32 v87, v87, v27
    v_exp_f32 v80, v80
    v_exp_f32 v81, v81
    v_exp_f32 v82, v82
    v_exp_f32 v83, v83
    v_exp_f32 v84, v84
    v_exp_f32 v85, v85
    v_exp_f32 v86, v86
    v_exp_f32 v87, v87
    v_add_f32 v80, 1.0, v80
    v_add_f32 v81, 1.0, v81
    v_add_f32 v82, 1.0, v82
    v_add_f32 v83, 1.0, v83
    v_add_f32 v84, 1.0, v84
    v_add_f32 v85, 1.0, v85
    v_add_f32 v86, 1.0, v86
    v_add_f32 v87, 1.0, v87
    v_rcp_f32 v80, v80
    v_rcp_f32 v81, v81
    v_rcp_f32 v82, v82
    v_rcp_f32 v83, v83
    v_rcp_f32 v84, v84
    v_rcp_f32 v85, v85
    v_rcp_f32 v86, v86
    v_rcp_f32 v87, v87
    v_mul_f32 v80, v80, v8
    v_mul_f32 v81, v81, v9
    v_mul_f32 v82, v82, v10
    v_mul_f32 v83, v83, v11
    v_mul_f32 v84, v84, v24
    v_mul_f32 v85, v85, v25
    v_mul_f32 v86, v86, v26
    v_mul_f32 v87, v87, v27
    v_cvt_pk_bf16_f32 v56, v80, v81
    v_cvt_pk_bf16_f32 v57, v82, v83
    v_cvt_pk_bf16_f32 v58, v84, v85
    v_cvt_pk_bf16_f32 v59, v86, v87
    v_mul_f32 v80, v40, v40
    v_mul_f32 v81, v41, v41
    v_mul_f32 v82, v42, v42
    v_mul_f32 v83, v43, v43
    v_mul_f32 v84, v12, v12
    v_mul_f32 v85, v13, v13
    v_mul_f32 v86, v14, v14
    v_mul_f32 v87, v15, v15
    v_fmaak_f32 v80, v80, v160, 0xc0135761
    v_fmaak_f32 v81, v81, v160, 0xc0135761
    v_fmaak_f32 v82, v82, v160, 0xc0135761
    v_fmaak_f32 v83, v83, v160, 0xc0135761
    v_fmaak_f32 v84, v84, v160, 0xc0135761
    v_fmaak_f32 v85, v85, v160, 0xc0135761
    v_fmaak_f32 v86, v86, v160, 0xc0135761
    v_fmaak_f32 v87, v87, v160, 0xc0135761
    v_mul_f32 v80, v80, v40
    v_mul_f32 v81, v81, v41
    v_mul_f32 v82, v82, v42
    v_mul_f32 v83, v83, v43
    v_mul_f32 v84, v84, v12
    v_mul_f32 v85, v85, v13
    v_mul_f32 v86, v86, v14
    v_mul_f32 v87, v87, v15
    v_exp_f32 v80, v80
    v_exp_f32 v81, v81
    v_exp_f32 v82, v82
    v_exp_f32 v83, v83
    v_exp_f32 v84, v84
    v_exp_f32 v85, v85
    v_exp_f32 v86, v86
    v_exp_f32 v87, v87
    v_add_f32 v80, 1.0, v80
    v_add_f32 v81, 1.0, v81
    v_add_f32 v82, 1.0, v82
    v_add_f32 v83, 1.0, v83
    v_add_f32 v84, 1.0, v84
    v_add_f32 v85, 1.0, v85
    v_add_f32 v86, 1.0, v86
    v_add_f32 v87, 1.0, v87
    v_rcp_f32 v80, v80
    v_rcp_f32 v81, v81
    v_rcp_f32 v82, v82
    v_rcp_f32 v83, v83
    v_rcp_f32 v84, v84
    v_rcp_f32 v85, v85
    v_rcp_f32 v86, v86
    v_rcp_f32 v87, v87
    v_mul_f32 v80, v80, v40
    v_mul_f32 v81, v81, v41
    v_mul_f32 v82, v82, v42
    v_mul_f32 v83, v83, v43
    v_mul_f32 v84, v84, v12
    v_mul_f32 v85, v85, v13
    v_mul_f32 v86, v86, v14
    v_mul_f32 v87, v87, v15
    v_cvt_pk_bf16_f32 v60, v80, v81
    v_cvt_pk_bf16_f32 v61, v82, v83
    v_cvt_pk_bf16_f32 v62, v84, v85
    v_cvt_pk_bf16_f32 v63, v86, v87
    v_mul_f32 v80, v28, v28
    v_mul_f32 v81, v29, v29
    v_mul_f32 v82, v30, v30
    v_mul_f32 v83, v31, v31
    v_mul_f32 v84, v44, v44
    v_mul_f32 v85, v45, v45
    v_mul_f32 v86, v46, v46
    v_mul_f32 v87, v47, v47
    v_fmaak_f32 v80, v80, v160, 0xc0135761
    v_fmaak_f32 v81, v81, v160, 0xc0135761
    v_fmaak_f32 v82, v82, v160, 0xc0135761
    v_fmaak_f32 v83, v83, v160, 0xc0135761
    v_fmaak_f32 v84, v84, v160, 0xc0135761
    v_fmaak_f32 v85, v85, v160, 0xc0135761
    v_fmaak_f32 v86, v86, v160, 0xc0135761
    v_fmaak_f32 v87, v87, v160, 0xc0135761
    v_mul_f32 v80, v80, v28
    v_mul_f32 v81, v81, v29
    v_mul_f32 v82, v82, v30
    v_mul_f32 v83, v83, v31
    v_mul_f32 v84, v84, v44
    v_mul_f32 v85, v85, v45
    v_mul_f32 v86, v86, v46
    v_mul_f32 v87, v87, v47
    v_exp_f32 v80, v80
    v_exp_f32 v81, v81
    v_exp_f32 v82, v82
    v_exp_f32 v83, v83
    v_exp_f32 v84, v84
    v_exp_f32 v85, v85
    v_exp_f32 v86, v86
    v_exp_f32 v87, v87
    v_add_f32 v80, 1.0, v80
    v_add_f32 v81, 1.0, v81
    v_add_f32 v82, 1.0, v82
    v_add_f32 v83, 1.0, v83
    v_add_f32 v84, 1.0, v84
    v_add_f32 v85, 1.0, v85
    v_add_f32 v86, 1.0, v86
    v_add_f32 v87, 1.0, v87
    v_rcp_f32 v80, v80
    v_rcp_f32 v81, v81
    v_rcp_f32 v82, v82
    v_rcp_f32 v83, v83
    v_rcp_f32 v84, v84
    v_rcp_f32 v85, v85
    v_rcp_f32 v86, v86
    v_rcp_f32 v87, v87
    v_mul_f32 v80, v80, v28
    v_mul_f32 v81, v81, v29
    v_mul_f32 v82, v82, v30
    v_mul_f32 v83, v83, v31
    v_mul_f32 v84, v84, v44
    v_mul_f32 v85, v85, v45
    v_mul_f32 v86, v86, v46
    v_mul_f32 v87, v87, v47
    v_cvt_pk_bf16_f32 v64, v80, v81
    v_cvt_pk_bf16_f32 v65, v82, v83
    v_cvt_pk_bf16_f32 v66, v84, v85
    v_cvt_pk_bf16_f32 v67, v86, v87
    v_mul_f32 v80, v16, v16
    v_mul_f32 v81, v17, v17
    v_mul_f32 v82, v18, v18
    v_mul_f32 v83, v19, v19
    v_mul_f32 v84, v32, v32
    v_mul_f32 v85, v33, v33
    v_mul_f32 v86, v34, v34
    v_mul_f32 v87, v35, v35
    v_fmaak_f32 v80, v80, v160, 0xc0135761
    v_fmaak_f32 v81, v81, v160, 0xc0135761
    v_fmaak_f32 v82, v82, v160, 0xc0135761
    v_fmaak_f32 v83, v83, v160, 0xc0135761
    v_fmaak_f32 v84, v84, v160, 0xc0135761
    v_fmaak_f32 v85, v85, v160, 0xc0135761
    v_fmaak_f32 v86, v86, v160, 0xc0135761
    v_fmaak_f32 v87, v87, v160, 0xc0135761
    v_mul_f32 v80, v80, v16
    v_mul_f32 v81, v81, v17
    v_mul_f32 v82, v82, v18
    v_mul_f32 v83, v83, v19
    v_mul_f32 v84, v84, v32
    v_mul_f32 v85, v85, v33
    v_mul_f32 v86, v86, v34
    v_mul_f32 v87, v87, v35
    v_exp_f32 v80, v80
    v_exp_f32 v81, v81
    v_exp_f32 v82, v82
    v_exp_f32 v83, v83
    v_exp_f32 v84, v84
    v_exp_f32 v85, v85
    v_exp_f32 v86, v86
    v_exp_f32 v87, v87
    v_add_f32 v80, 1.0, v80
    v_add_f32 v81, 1.0, v81
    v_add_f32 v82, 1.0, v82
    v_add_f32 v83, 1.0, v83
    v_add_f32 v84, 1.0, v84
    v_add_f32 v85, 1.0, v85
    v_add_f32 v86, 1.0, v86
    v_add_f32 v87, 1.0, v87
    v_rcp_f32 v80, v80
    v_rcp_f32 v81, v81
    v_rcp_f32 v82, v82
    v_rcp_f32 v83, v83
    v_rcp_f32 v84, v84
    v_rcp_f32 v85, v85
    v_rcp_f32 v86, v86
    v_rcp_f32 v87, v87
    v_mul_f32 v80, v80, v16
    v_mul_f32 v81, v81, v17
    v_mul_f32 v82, v82, v18
    v_mul_f32 v83, v83, v19
    v_mul_f32 v84, v84, v32
    v_mul_f32 v85, v85, v33
    v_mul_f32 v86, v86, v34
    v_mul_f32 v87, v87, v35
    v_cvt_pk_bf16_f32 v68, v80, v81
    v_cvt_pk_bf16_f32 v69, v82, v83
    v_cvt_pk_bf16_f32 v70, v84, v85
    v_cvt_pk_bf16_f32 v71, v86, v87
    v_mul_f32 v80, v48, v48
    v_mul_f32 v81, v49, v49
    v_mul_f32 v82, v50, v50
    v_mul_f32 v83, v51, v51
    v_mul_f32 v84, v20, v20
    v_mul_f32 v85, v21, v21
    v_mul_f32 v86, v22, v22
    v_mul_f32 v87, v23, v23
    v_fmaak_f32 v80, v80, v160, 0xc0135761
    v_fmaak_f32 v81, v81, v160, 0xc0135761
    v_fmaak_f32 v82, v82, v160, 0xc0135761
    v_fmaak_f32 v83, v83, v160, 0xc0135761
    v_fmaak_f32 v84, v84, v160, 0xc0135761
    v_fmaak_f32 v85, v85, v160, 0xc0135761
    v_fmaak_f32 v86, v86, v160, 0xc0135761
    v_fmaak_f32 v87, v87, v160, 0xc0135761
    v_mul_f32 v80, v80, v48
    v_mul_f32 v81, v81, v49
    v_mul_f32 v82, v82, v50
    v_mul_f32 v83, v83, v51
    v_mul_f32 v84, v84, v20
    v_mul_f32 v85, v85, v21
    v_mul_f32 v86, v86, v22
    v_mul_f32 v87, v87, v23
    v_exp_f32 v80, v80
    v_exp_f32 v81, v81
    v_exp_f32 v82, v82
    v_exp_f32 v83, v83
    v_exp_f32 v84, v84
    v_exp_f32 v85, v85
    v_exp_f32 v86, v86
    v_exp_f32 v87, v87
    v_add_f32 v80, 1.0, v80
    v_add_f32 v81, 1.0, v81
    v_add_f32 v82, 1.0, v82
    v_add_f32 v83, 1.0, v83
    v_add_f32 v84, 1.0, v84
    v_add_f32 v85, 1.0, v85
    v_add_f32 v86, 1.0, v86
    v_add_f32 v87, 1.0, v87
    v_rcp_f32 v80, v80
    v_rcp_f32 v81, v81
    v_rcp_f32 v82, v82
    v_rcp_f32 v83, v83
    v_rcp_f32 v84, v84
    v_rcp_f32 v85, v85
    v_rcp_f32 v86, v86
    v_rcp_f32 v87, v87
    v_mul_f32 v80, v80, v48
    v_mul_f32 v81, v81, v49
    v_mul_f32 v82, v82, v50
    v_mul_f32 v83, v83, v51
    v_mul_f32 v84, v84, v20
    v_mul_f32 v85, v85, v21
    v_mul_f32 v86, v86, v22
    v_mul_f32 v87, v87, v23
    v_cvt_pk_bf16_f32 v72, v80, v81
    v_cvt_pk_bf16_f32 v73, v82, v83
    v_cvt_pk_bf16_f32 v74, v84, v85
    v_cvt_pk_bf16_f32 v75, v86, v87
    v_mul_f32 v80, v36, v36
    v_mul_f32 v81, v37, v37
    v_mul_f32 v82, v38, v38
    v_mul_f32 v83, v39, v39
    v_mul_f32 v84, v52, v52
    v_mul_f32 v85, v53, v53
    v_mul_f32 v86, v54, v54
    v_mul_f32 v87, v55, v55
    v_fmaak_f32 v80, v80, v160, 0xc0135761
    v_fmaak_f32 v81, v81, v160, 0xc0135761
    v_fmaak_f32 v82, v82, v160, 0xc0135761
    v_fmaak_f32 v83, v83, v160, 0xc0135761
    v_fmaak_f32 v84, v84, v160, 0xc0135761
    v_fmaak_f32 v85, v85, v160, 0xc0135761
    v_fmaak_f32 v86, v86, v160, 0xc0135761
    v_fmaak_f32 v87, v87, v160, 0xc0135761
    v_mul_f32 v80, v80, v36
    v_mul_f32 v81, v81, v37
    v_mul_f32 v82, v82, v38
    v_mul_f32 v83, v83, v39
    v_mul_f32 v84, v84, v52
    v_mul_f32 v85, v85, v53
    v_mul_f32 v86, v86, v54
    v_mul_f32 v87, v87, v55
    v_exp_f32 v80, v80
    v_exp_f32 v81, v81
    v_exp_f32 v82, v82
    v_exp_f32 v83, v83
    v_exp_f32 v84, v84
    v_exp_f32 v85, v85
    v_exp_f32 v86, v86
    v_exp_f32 v87, v87
    v_add_f32 v80, 1.0, v80
    v_add_f32 v81, 1.0, v81
    v_add_f32 v82, 1.0, v82
    v_add_f32 v83, 1.0, v83
    v_add_f32 v84, 1.0, v84
    v_add_f32 v85, 1.0, v85
    v_add_f32 v86, 1.0, v86
    v_add_f32 v87, 1.0, v87
    v_rcp_f32 v80, v80
    v_rcp_f32 v81, v81
    v_rcp_f32 v82, v82
    v_rcp_f32 v83, v83
    v_rcp_f32 v84, v84
    v_rcp_f32 v85, v85
    v_rcp_f32 v86, v86
    v_rcp_f32 v87, v87
    v_mul_f32 v80, v80, v36
    v_mul_f32 v81, v81, v37
    v_mul_f32 v82, v82, v38
    v_mul_f32 v83, v83, v39
    v_mul_f32 v84, v84, v52
    v_mul_f32 v85, v85, v53
    v_mul_f32 v86, v86, v54
    v_mul_f32 v87, v87, v55
    v_cvt_pk_bf16_f32 v76, v80, v81
    v_cvt_pk_bf16_f32 v77, v82, v83
    v_cvt_pk_bf16_f32 v78, v84, v85
    v_cvt_pk_bf16_f32 v79, v86, v87
    s_mul_i32 s35, s3, 3
    s_lshr_b32 s35, s35, 1
    s_lshl_b32 s36, s35, 12
    v_add_u32 v2, s36, v4
    s_bitcmp1_b32 s3, 0
    s_cbranch_scc1 C_odd_11
    ds_write_b128 v2, v[56:59] offset:0
    ds_write_b64 v2, v[60:61] offset:4096
    ds_write_b128 v2, v[62:65] offset:1024
    ds_write_b64 v2, v[66:67] offset:5120
    ds_write_b128 v2, v[68:71] offset:2048
    ds_write_b64 v2, v[72:73] offset:6144
    ds_write_b128 v2, v[74:77] offset:3072
    ds_write_b64 v2, v[78:79] offset:7168
    s_branch C_end_12
C_odd_11:
    ds_write_b64 v2, v[56:57] offset:8
    ds_write_b128 v2, v[58:61] offset:4096
    ds_write_b64 v2, v[62:63] offset:1032
    ds_write_b128 v2, v[64:67] offset:5120
    ds_write_b64 v2, v[68:69] offset:2056
    ds_write_b128 v2, v[70:73] offset:6144
    ds_write_b64 v2, v[74:75] offset:3080
    ds_write_b128 v2, v[76:79] offset:7168
C_end_12:
    s_waitcnt lgkmcnt(0)
    s_lshl_b32 s36, s27, 2
    v_add_u32 v2, s36, v6
    s_mov_b64 exec, 1
    ds_add_u32 v2, v7
    s_mov_b64 exec, -1
    s_setprio 1
C_poll_13:
    ds_read_b32 v2, v6 offset:0
    s_waitcnt lgkmcnt(0)
    v_readfirstlane_b32 s38, v2
    s_nop 0
    s_cmp_ge_u32 s38, 4
    s_cbranch_scc1 C_go_14
    s_sleep 2
    s_branch C_poll_13
C_go_14:
    ds_read_b128 v[56:59], v4 offset:0
    ds_read_b128 v[60:63], v4 offset:1024
    ds_read_b128 v[64:67], v4 offset:2048
    ds_read_b128 v[68:71], v4 offset:3072
    s_waitcnt vmcnt(12) lgkmcnt(0)
    v_mfma_f32_16x16x32_bf16 v[8:11], v[124:127], v[56:59], 0
    ds_read_b128 v[72:75], v4 offset:4096
    v_mfma_f32_16x16x32_bf16 v[12:15], v[124:127], v[60:63], 0
    v_mfma_f32_16x16x32_bf16 v[16:19], v[124:127], v[64:67], 0
    ds_read_b128 v[76:79], v4 offset:5120
    v_mfma_f32_16x16x32_bf16 v[20:23], v[124:127], v[68:71], 0
    buffer_load_dwordx4 v[124:127], v1, s[4:7], s40 offen offset:0
    v_mfma_f32_16x16x32_bf16 v[24:27], v[128:131], v[56:59], 0
    ds_read_b128 v[80:83], v4 offset:6144
    v_mfma_f32_16x16x32_bf16 v[28:31], v[128:131], v[60:63], 0
    v_mfma_f32_16x16x32_bf16 v[32:35], v[128:131], v[64:67], 0
    ds_read_b128 v[84:87], v4 offset:7168
    v_mfma_f32_16x16x32_bf16 v[36:39], v[128:131], v[68:71], 0
    buffer_load_dwordx4 v[128:131], v1, s[4:7], s40 offen offset:1024
    v_mfma_f32_16x16x32_bf16 v[40:43], v[132:135], v[56:59], 0
    v_mfma_f32_16x16x32_bf16 v[44:47], v[132:135], v[60:63], 0
    v_mfma_f32_16x16x32_bf16 v[48:51], v[132:135], v[64:67], 0
    v_mfma_f32_16x16x32_bf16 v[52:55], v[132:135], v[68:71], 0
    buffer_load_dwordx4 v[132:135], v1, s[4:7], s40 offen offset:2048
    s_add_u32 s40, s40, 3072
    s_waitcnt vmcnt(12) lgkmcnt(0)
    v_mfma_f32_16x16x32_bf16 v[8:11], v[136:139], v[72:75], v[8:11]
    ds_read_b128 v[56:59], v4 offset:8192
    v_mfma_f32_16x16x32_bf16 v[12:15], v[136:139], v[76:79], v[12:15]
    v_mfma_f32_16x16x32_bf16 v[16:19], v[136:139], v[80:83], v[16:19]
    ds_read_b128 v[60:63], v4 offset:9216
    v_mfma_f32_16x16x32_bf16 v[20:23], v[136:139], v[84:87], v[20:23]
    buffer_load_dwordx4 v[136:139], v1, s[4:7], s40 offen offset:0
    v_mfma_f32_16x16x32_bf16 v[24:27], v[140:143], v[72:75], v[24:27]
    ds_read_b128 v[64:67], v4 offset:10240
    v_mfma_f32_16x16x32_bf16 v[28:31], v[140:143], v[76:79], v[28:31]
    v_mfma_f32_16x16x32_bf16 v[32:35], v[140:143], v[80:83], v[32:35]
    ds_read_b128 v[68:71], v4 offset:11264
    v_mfma_f32_16x16x32_bf16 v[36:39], v[140:143], v[84:87], v[36:39]
    buffer_load_dwordx4 v[140:143], v1, s[4:7], s40 offen offset:1024
    v_mfma_f32_16x16x32_bf16 v[40:43], v[144:147], v[72:75], v[40:43]
    v_mfma_f32_16x16x32_bf16 v[44:47], v[144:147], v[76:79], v[44:47]
    v_mfma_f32_16x16x32_bf16 v[48:51], v[144:147], v[80:83], v[48:51]
    v_mfma_f32_16x16x32_bf16 v[52:55], v[144:147], v[84:87], v[52:55]
    buffer_load_dwordx4 v[144:147], v1, s[4:7], s40 offen offset:2048
    s_add_u32 s40, s40, 3072
    s_waitcnt vmcnt(12) lgkmcnt(0)
    v_mfma_f32_16x16x32_bf16 v[8:11], v[88:91], v[56:59], v[8:11]
    ds_read_b128 v[72:75], v4 offset:12288
    v_mfma_f32_16x16x32_bf16 v[12:15], v[88:91], v[60:63], v[12:15]
    v_mfma_f32_16x16x32_bf16 v[16:19], v[88:91], v[64:67], v[16:19]
    ds_read_b128 v[76:79], v4 offset:13312
    v_mfma_f32_16x16x32_bf16 v[20:23], v[88:91], v[68:71], v[20:23]
    buffer_load_dwordx4 v[88:91], v1, s[4:7], s40 offen offset:0
    v_mfma_f32_16x16x32_bf16 v[24:27], v[92:95], v[56:59], v[24:27]
    ds_read_b128 v[80:83], v4 offset:14336
    v_mfma_f32_16x16x32_bf16 v[28:31], v[92:95], v[60:63], v[28:31]
    v_mfma_f32_16x16x32_bf16 v[32:35], v[92:95], v[64:67], v[32:35]
    ds_read_b128 v[84:87], v4 offset:15360
    v_mfma_f32_16x16x32_bf16 v[36:39], v[92:95], v[68:71], v[36:39]
    buffer_load_dwordx4 v[92:95], v1, s[4:7], s40 offen offset:1024
    v_mfma_f32_16x16x32_bf16 v[40:43], v[96:99], v[56:59], v[40:43]
    v_mfma_f32_16x16x32_bf16 v[44:47], v[96:99], v[60:63], v[44:47]
    v_mfma_f32_16x16x32_bf16 v[48:51], v[96:99], v[64:67], v[48:51]
    v_mfma_f32_16x16x32_bf16 v[52:55], v[96:99], v[68:71], v[52:55]
    buffer_load_dwordx4 v[96:99], v1, s[4:7], s40 offen offset:2048
    s_add_u32 s40, s40, 3072
    s_waitcnt vmcnt(12) lgkmcnt(0)
    v_mfma_f32_16x16x32_bf16 v[8:11], v[100:103], v[72:75], v[8:11]
    ds_read_b128 v[56:59], v4 offset:16384
    v_mfma_f32_16x16x32_bf16 v[12:15], v[100:103], v[76:79], v[12:15]
    v_mfma_f32_16x16x32_bf16 v[16:19], v[100:103], v[80:83], v[16:19]
    ds_read_b128 v[60:63], v4 offset:17408
    v_mfma_f32_16x16x32_bf16 v[20:23], v[100:103], v[84:87], v[20:23]
    buffer_load_dwordx4 v[100:103], v1, s[4:7], s40 offen offset:0
    v_mfma_f32_16x16x32_bf16 v[24:27], v[104:107], v[72:75], v[24:27]
    ds_read_b128 v[64:67], v4 offset:18432
    v_mfma_f32_16x16x32_bf16 v[28:31], v[104:107], v[76:79], v[28:31]
    v_mfma_f32_16x16x32_bf16 v[32:35], v[104:107], v[80:83], v[32:35]
    ds_read_b128 v[68:71], v4 offset:19456
    v_mfma_f32_16x16x32_bf16 v[36:39], v[104:107], v[84:87], v[36:39]
    buffer_load_dwordx4 v[104:107], v1, s[4:7], s40 offen offset:1024
    v_mfma_f32_16x16x32_bf16 v[40:43], v[108:111], v[72:75], v[40:43]
    v_mfma_f32_16x16x32_bf16 v[44:47], v[108:111], v[76:79], v[44:47]
    v_mfma_f32_16x16x32_bf16 v[48:51], v[108:111], v[80:83], v[48:51]
    v_mfma_f32_16x16x32_bf16 v[52:55], v[108:111], v[84:87], v[52:55]
    buffer_load_dwordx4 v[108:111], v1, s[4:7], s40 offen offset:2048
    s_add_u32 s40, s40, 3072
    s_waitcnt vmcnt(12) lgkmcnt(0)
    v_mfma_f32_16x16x32_bf16 v[8:11], v[112:115], v[56:59], v[8:11]
    ds_read_b128 v[72:75], v4 offset:20480
    v_mfma_f32_16x16x32_bf16 v[12:15], v[112:115], v[60:63], v[12:15]
    v_mfma_f32_16x16x32_bf16 v[16:19], v[112:115], v[64:67], v[16:19]
    ds_read_b128 v[76:79], v4 offset:21504
    v_mfma_f32_16x16x32_bf16 v[20:23], v[112:115], v[68:71], v[20:23]
    buffer_load_dwordx4 v[112:115], v1, s[4:7], s40 offen offset:0
    v_mfma_f32_16x16x32_bf16 v[24:27], v[116:119], v[56:59], v[24:27]
    ds_read_b128 v[80:83], v4 offset:22528
    v_mfma_f32_16x16x32_bf16 v[28:31], v[116:119], v[60:63], v[28:31]
    v_mfma_f32_16x16x32_bf16 v[32:35], v[116:119], v[64:67], v[32:35]
    ds_read_b128 v[84:87], v4 offset:23552
    v_mfma_f32_16x16x32_bf16 v[36:39], v[116:119], v[68:71], v[36:39]
    buffer_load_dwordx4 v[116:119], v1, s[4:7], s40 offen offset:1024
    v_mfma_f32_16x16x32_bf16 v[40:43], v[120:123], v[56:59], v[40:43]
    v_mfma_f32_16x16x32_bf16 v[44:47], v[120:123], v[60:63], v[44:47]
    v_mfma_f32_16x16x32_bf16 v[48:51], v[120:123], v[64:67], v[48:51]
    v_mfma_f32_16x16x32_bf16 v[52:55], v[120:123], v[68:71], v[52:55]
    buffer_load_dwordx4 v[120:123], v1, s[4:7], s40 offen offset:2048
    s_add_u32 s40, s40, 3072
C_poll_15:
    ds_read_b32 v2, v6 offset:4
    s_waitcnt lgkmcnt(0)
    v_readfirstlane_b32 s38, v2
    s_nop 0
    s_cmp_ge_u32 s38, 4
    s_cbranch_scc1 C_go_16
    s_sleep 2
    s_branch C_poll_15
C_go_16:
    s_waitcnt vmcnt(12) lgkmcnt(0)
    v_mfma_f32_16x16x32_bf16 v[8:11], v[124:127], v[72:75], v[8:11]
    ds_read_b128 v[56:59], v4 offset:24576
    v_mfma_f32_16x16x32_bf16 v[12:15], v[124:127], v[76:79], v[12:15]
    v_mfma_f32_16x16x32_bf16 v[16:19], v[124:127], v[80:83], v[16:19]
    ds_read_b128 v[60:63], v4 offset:25600
    v_mfma_f32_16x16x32_bf16 v[20:23], v[124:127], v[84:87], v[20:23]
    buffer_load_dwordx4 v[124:127], v1, s[4:7], s40 offen offset:0
    v_mfma_f32_16x16x32_bf16 v[24:27], v[128:131], v[72:75], v[24:27]
    ds_read_b128 v[64:67], v4 offset:26624
    v_mfma_f32_16x16x32_bf16 v[28:31], v[128:131], v[76:79], v[28:31]
    v_mfma_f32_16x16x32_bf16 v[32:35], v[128:131], v[80:83], v[32:35]
    ds_read_b128 v[68:71], v4 offset:27648
    v_mfma_f32_16x16x32_bf16 v[36:39], v[128:131], v[84:87], v[36:39]
    buffer_load_dwordx4 v[128:131], v1, s[4:7], s40 offen offset:1024
    v_mfma_f32_16x16x32_bf16 v[40:43], v[132:135], v[72:75], v[40:43]
    v_mfma_f32_16x16x32_bf16 v[44:47], v[132:135], v[76:79], v[44:47]
    v_mfma_f32_16x16x32_bf16 v[48:51], v[132:135], v[80:83], v[48:51]
    v_mfma_f32_16x16x32_bf16 v[52:55], v[132:135], v[84:87], v[52:55]
    buffer_load_dwordx4 v[132:135], v1, s[4:7], s40 offen offset:2048
    s_add_u32 s40, s40, 3072
    s_waitcnt vmcnt(12) lgkmcnt(0)
    v_mfma_f32_16x16x32_bf16 v[8:11], v[136:139], v[56:59], v[8:11]
    ds_read_b128 v[72:75], v4 offset:28672
    v_mfma_f32_16x16x32_bf16 v[12:15], v[136:139], v[60:63], v[12:15]
    v_mfma_f32_16x16x32_bf16 v[16:19], v[136:139], v[64:67], v[16:19]
    ds_read_b128 v[76:79], v4 offset:29696
    v_mfma_f32_16x16x32_bf16 v[20:23], v[136:139], v[68:71], v[20:23]
    buffer_load_dwordx4 v[136:139], v1, s[4:7], s40 offen offset:0
    v_mfma_f32_16x16x32_bf16 v[24:27], v[140:143], v[56:59], v[24:27]
    ds_read_b128 v[80:83], v4 offset:30720
    v_mfma_f32_16x16x32_bf16 v[28:31], v[140:143], v[60:63], v[28:31]
    v_mfma_f32_16x16x32_bf16 v[32:35], v[140:143], v[64:67], v[32:35]
    ds_read_b128 v[84:87], v4 offset:31744
    v_mfma_f32_16x16x32_bf16 v[36:39], v[140:143], v[68:71], v[36:39]
    buffer_load_dwordx4 v[140:143], v1, s[4:7], s40 offen offset:1024
    v_mfma_f32_16x16x32_bf16 v[40:43], v[144:147], v[56:59], v[40:43]
    v_mfma_f32_16x16x32_bf16 v[44:47], v[144:147], v[60:63], v[44:47]
    v_mfma_f32_16x16x32_bf16 v[48:51], v[144:147], v[64:67], v[48:51]
    v_mfma_f32_16x16x32_bf16 v[52:55], v[144:147], v[68:71], v[52:55]
    buffer_load_dwordx4 v[144:147], v1, s[4:7], s40 offen offset:2048
    s_add_u32 s40, s40, 3072
    s_waitcnt vmcnt(12) lgkmcnt(0)
    v_mfma_f32_16x16x32_bf16 v[8:11], v[88:91], v[72:75], v[8:11]
    ds_read_b128 v[56:59], v4 offset:32768
    v_mfma_f32_16x16x32_bf16 v[12:15], v[88:91], v[76:79], v[12:15]
    v_mfma_f32_16x16x32_bf16 v[16:19], v[88:91], v[80:83], v[16:19]
    ds_read_b128 v[60:63], v4 offset:33792
    v_mfma_f32_16x16x32_bf16 v[20:23], v[88:91], v[84:87], v[20:23]
    buffer_load_dwordx4 v[88:91], v1, s[4:7], s40 offen offset:0
    v_mfma_f32_16x16x32_bf16 v[24:27], v[92:95], v[72:75], v[24:27]
    ds_read_b128 v[64:67], v4 offset:34816
    v_mfma_f32_16x16x32_bf16 v[28:31], v[92:95], v[76:79], v[28:31]
    v_mfma_f32_16x16x32_bf16 v[32:35], v[92:95], v[80:83], v[32:35]
    ds_read_b128 v[68:71], v4 offset:35840
    v_mfma_f32_16x16x32_bf16 v[36:39], v[92:95], v[84:87], v[36:39]
    buffer_load_dwordx4 v[92:95], v1, s[4:7], s40 offen offset:1024
    v_mfma_f32_16x16x32_bf16 v[40:43], v[96:99], v[72:75], v[40:43]
    v_mfma_f32_16x16x32_bf16 v[44:47], v[96:99], v[76:79], v[44:47]
    v_mfma_f32_16x16x32_bf16 v[48:51], v[96:99], v[80:83], v[48:51]
    v_mfma_f32_16x16x32_bf16 v[52:55], v[96:99], v[84:87], v[52:55]
    buffer_load_dwordx4 v[96:99], v1, s[4:7], s40 offen offset:2048
    s_add_u32 s40, s40, 3072
    s_waitcnt vmcnt(12) lgkmcnt(0)
    v_mfma_f32_16x16x32_bf16 v[8:11], v[100:103], v[56:59], v[8:11]
    ds_read_b128 v[72:75], v4 offset:36864
    v_mfma_f32_16x16x32_bf16 v[12:15], v[100:103], v[60:63], v[12:15]
    v_mfma_f32_16x16x32_bf16 v[16:19], v[100:103], v[64:67], v[16:19]
    ds_read_b128 v[76:79], v4 offset:37888
    v_mfma_f32_16x16x32_bf16 v[20:23], v[100:103], v[68:71], v[20:23]
    buffer_load_dwordx4 v[100:103], v1, s[4:7], s40 offen offset:0
    v_mfma_f32_16x16x32_bf16 v[24:27], v[104:107], v[56:59], v[24:27]
    ds_read_b128 v[80:83], v4 offset:38912
    v_mfma_f32_16x16x32_bf16 v[28:31], v[104:107], v[60:63], v[28:31]
    v_mfma_f32_16x16x32_bf16 v[32:35], v[104:107], v[64:67], v[32:35]
    ds_read_b128 v[84:87], v4 offset:39936
    v_mfma_f32_16x16x32_bf16 v[36:39], v[104:107], v[68:71], v[36:39]
    buffer_load_dwordx4 v[104:107], v1, s[4:7], s40 offen offset:1024
    v_mfma_f32_16x16x32_bf16 v[40:43], v[108:111], v[56:59], v[40:43]
    v_mfma_f32_16x16x32_bf16 v[44:47], v[108:111], v[60:63], v[44:47]
    v_mfma_f32_16x16x32_bf16 v[48:51], v[108:111], v[64:67], v[48:51]
    v_mfma_f32_16x16x32_bf16 v[52:55], v[108:111], v[68:71], v[52:55]
    buffer_load_dwordx4 v[108:111], v1, s[4:7], s40 offen offset:2048
    s_add_u32 s40, s40, 3072
    s_waitcnt vmcnt(12) lgkmcnt(0)
    v_mfma_f32_16x16x32_bf16 v[8:11], v[112:115], v[72:75], v[8:11]
    ds_read_b128 v[56:59], v4 offset:40960
    v_mfma_f32_16x16x32_bf16 v[12:15], v[112:115], v[76:79], v[12:15]
    v_mfma_f32_16x16x32_bf16 v[16:19], v[112:115], v[80:83], v[16:19]
    ds_read_b128 v[60:63], v4 offset:41984
    v_mfma_f32_16x16x32_bf16 v[20:23], v[112:115], v[84:87], v[20:23]
    buffer_load_dwordx4 v[112:115], v1, s[4:7], s40 offen offset:0
    v_mfma_f32_16x16x32_bf16 v[24:27], v[116:119], v[72:75], v[24:27]
    ds_read_b128 v[64:67], v4 offset:43008
    v_mfma_f32_16x16x32_bf16 v[28:31], v[116:119], v[76:79], v[28:31]
    v_mfma_f32_16x16x32_bf16 v[32:35], v[116:119], v[80:83], v[32:35]
    ds_read_b128 v[68:71], v4 offset:44032
    v_mfma_f32_16x16x32_bf16 v[36:39], v[116:119], v[84:87], v[36:39]
    buffer_load_dwordx4 v[116:119], v1, s[4:7], s40 offen offset:1024
    v_mfma_f32_16x16x32_bf16 v[40:43], v[120:123], v[72:75], v[40:43]
    v_mfma_f32_16x16x32_bf16 v[44:47], v[120:123], v[76:79], v[44:47]
    v_mfma_f32_16x16x32_bf16 v[48:51], v[120:123], v[80:83], v[48:51]
    v_mfma_f32_16x16x32_bf16 v[52:55], v[120:123], v[84:87], v[52:55]
    buffer_load_dwordx4 v[120:123], v1, s[4:7], s40 offen offset:2048
    s_add_u32 s40, s40, 3072
    s_waitcnt vmcnt(12) lgkmcnt(0)
    v_mfma_f32_16x16x32_bf16 v[8:11], v[124:127], v[56:59], v[8:11]
    ds_read_b128 v[72:75], v4 offset:45056
    v_mfma_f32_16x16x32_bf16 v[12:15], v[124:127], v[60:63], v[12:15]
    v_mfma_f32_16x16x32_bf16 v[16:19], v[124:127], v[64:67], v[16:19]
    ds_read_b128 v[76:79], v4 offset:46080
    v_mfma_f32_16x16x32_bf16 v[20:23], v[124:127], v[68:71], v[20:23]
    buffer_load_dwordx4 v[124:127], v1, s[4:7], s40 offen offset:0
    v_mfma_f32_16x16x32_bf16 v[24:27], v[128:131], v[56:59], v[24:27]
    ds_read_b128 v[80:83], v4 offset:47104
    v_mfma_f32_16x16x32_bf16 v[28:31], v[128:131], v[60:63], v[28:31]
    v_mfma_f32_16x16x32_bf16 v[32:35], v[128:131], v[64:67], v[32:35]
    ds_read_b128 v[84:87], v4 offset:48128
    v_mfma_f32_16x16x32_bf16 v[36:39], v[128:131], v[68:71], v[36:39]
    buffer_load_dwordx4 v[128:131], v1, s[4:7], s40 offen offset:1024
    v_mfma_f32_16x16x32_bf16 v[40:43], v[132:135], v[56:59], v[40:43]
    v_mfma_f32_16x16x32_bf16 v[44:47], v[132:135], v[60:63], v[44:47]
    v_mfma_f32_16x16x32_bf16 v[48:51], v[132:135], v[64:67], v[48:51]
    v_mfma_f32_16x16x32_bf16 v[52:55], v[132:135], v[68:71], v[52:55]
    buffer_load_dwordx4 v[132:135], v1, s[4:7], s40 offen offset:2048
    s_add_u32 s40, s40, 3072
C_poll_17:
    ds_read_b32 v2, v6 offset:8
    s_waitcnt lgkmcnt(0)
    v_readfirstlane_b32 s38, v2
    s_nop 0
    s_cmp_ge_u32 s38, 4
    s_cbranch_scc1 C_go_18
    s_sleep 2
    s_branch C_poll_17
C_go_18:
    s_waitcnt vmcnt(12) lgkmcnt(0)
    v_mfma_f32_16x16x32_bf16 v[8:11], v[136:139], v[72:75], v[8:11]
    ds_read_b128 v[56:59], v4 offset:49152
    v_mfma_f32_16x16x32_bf16 v[12:15], v[136:139], v[76:79], v[12:15]
    v_mfma_f32_16x16x32_bf16 v[16:19], v[136:139], v[80:83], v[16:19]
    ds_read_b128 v[60:63], v4 offset:50176
    v_mfma_f32_16x16x32_bf16 v[20:23], v[136:139], v[84:87], v[20:23]
    buffer_load_dwordx4 v[136:139], v1, s[4:7], s40 offen offset:0
    v_mfma_f32_16x16x32_bf16 v[24:27], v[140:143], v[72:75], v[24:27]
    ds_read_b128 v[64:67], v4 offset:51200
    v_mfma_f32_16x16x32_bf16 v[28:31], v[140:143], v[76:79], v[28:31]
    v_mfma_f32_16x16x32_bf16 v[32:35], v[140:143], v[80:83], v[32:35]
    ds_read_b128 v[68:71], v4 offset:52224
    v_mfma_f32_16x16x32_bf16 v[36:39], v[140:143], v[84:87], v[36:39]
    buffer_load_dwordx4 v[140:143], v1, s[4:7], s40 offen offset:1024
    v_mfma_f32_16x16x32_bf16 v[40:43], v[144:147], v[72:75], v[40:43]
    v_mfma_f32_16x16x32_bf16 v[44:47], v[144:147], v[76:79], v[44:47]
    v_mfma_f32_16x16x32_bf16 v[48:51], v[144:147], v[80:83], v[48:51]
    v_mfma_f32_16x16x32_bf16 v[52:55], v[144:147], v[84:87], v[52:55]
    buffer_load_dwordx4 v[144:147], v1, s[4:7], s40 offen offset:2048
    s_add_u32 s40, s40, 3072
    s_waitcnt vmcnt(12) lgkmcnt(0)
    v_mfma_f32_16x16x32_bf16 v[8:11], v[88:91], v[56:59], v[8:11]
    ds_read_b128 v[72:75], v4 offset:53248
    v_mfma_f32_16x16x32_bf16 v[12:15], v[88:91], v[60:63], v[12:15]
    v_mfma_f32_16x16x32_bf16 v[16:19], v[88:91], v[64:67], v[16:19]
    ds_read_b128 v[76:79], v4 offset:54272
    v_mfma_f32_16x16x32_bf16 v[20:23], v[88:91], v[68:71], v[20:23]
    buffer_load_dwordx4 v[88:91], v1, s[4:7], s40 offen offset:0
    v_mfma_f32_16x16x32_bf16 v[24:27], v[92:95], v[56:59], v[24:27]
    ds_read_b128 v[80:83], v4 offset:55296
    v_mfma_f32_16x16x32_bf16 v[28:31], v[92:95], v[60:63], v[28:31]
    v_mfma_f32_16x16x32_bf16 v[32:35], v[92:95], v[64:67], v[32:35]
    ds_read_b128 v[84:87], v4 offset:56320
    v_mfma_f32_16x16x32_bf16 v[36:39], v[92:95], v[68:71], v[36:39]
    buffer_load_dwordx4 v[92:95], v1, s[4:7], s40 offen offset:1024
    v_mfma_f32_16x16x32_bf16 v[40:43], v[96:99], v[56:59], v[40:43]
    v_mfma_f32_16x16x32_bf16 v[44:47], v[96:99], v[60:63], v[44:47]
    v_mfma_f32_16x16x32_bf16 v[48:51], v[96:99], v[64:67], v[48:51]
    v_mfma_f32_16x16x32_bf16 v[52:55], v[96:99], v[68:71], v[52:55]
    buffer_load_dwordx4 v[96:99], v1, s[4:7], s40 offen offset:2048
    s_waitcnt vmcnt(12) lgkmcnt(0)
    v_mfma_f32_16x16x32_bf16 v[8:11], v[100:103], v[72:75], v[8:11]
    ds_read_b128 v[56:59], v4 offset:57344
    v_mfma_f32_16x16x32_bf16 v[12:15], v[100:103], v[76:79], v[12:15]
    v_mfma_f32_16x16x32_bf16 v[16:19], v[100:103], v[80:83], v[16:19]
    ds_read_b128 v[60:63], v4 offset:58368
    v_mfma_f32_16x16x32_bf16 v[20:23], v[100:103], v[84:87], v[20:23]
    v_mfma_f32_16x16x32_bf16 v[24:27], v[104:107], v[72:75], v[24:27]
    ds_read_b128 v[64:67], v4 offset:59392
    v_mfma_f32_16x16x32_bf16 v[28:31], v[104:107], v[76:79], v[28:31]
    v_mfma_f32_16x16x32_bf16 v[32:35], v[104:107], v[80:83], v[32:35]
    ds_read_b128 v[68:71], v4 offset:60416
    v_mfma_f32_16x16x32_bf16 v[36:39], v[104:107], v[84:87], v[36:39]
    v_mfma_f32_16x16x32_bf16 v[40:43], v[108:111], v[72:75], v[40:43]
    v_mfma_f32_16x16x32_bf16 v[44:47], v[108:111], v[76:79], v[44:47]
    v_mfma_f32_16x16x32_bf16 v[48:51], v[108:111], v[80:83], v[48:51]
    v_mfma_f32_16x16x32_bf16 v[52:55], v[108:111], v[84:87], v[52:55]
    s_waitcnt vmcnt(9) lgkmcnt(0)
    v_mfma_f32_16x16x32_bf16 v[8:11], v[112:115], v[56:59], v[8:11]
    ds_read_b128 v[72:75], v4 offset:61440
    v_mfma_f32_16x16x32_bf16 v[12:15], v[112:115], v[60:63], v[12:15]
    v_mfma_f32_16x16x32_bf16 v[16:19], v[112:115], v[64:67], v[16:19]
    ds_read_b128 v[76:79], v4 offset:62464
    v_mfma_f32_16x16x32_bf16 v[20:23], v[112:115], v[68:71], v[20:23]
    v_mfma_f32_16x16x32_bf16 v[24:27], v[116:119], v[56:59], v[24:27]
    ds_read_b128 v[80:83], v4 offset:63488
    v_mfma_f32_16x16x32_bf16 v[28:31], v[116:119], v[60:63], v[28:31]
    v_mfma_f32_16x16x32_bf16 v[32:35], v[116:119], v[64:67], v[32:35]
    ds_read_b128 v[84:87], v4 offset:64512
    v_mfma_f32_16x16x32_bf16 v[36:39], v[116:119], v[68:71], v[36:39]
    v_mfma_f32_16x16x32_bf16 v[40:43], v[120:123], v[56:59], v[40:43]
    v_mfma_f32_16x16x32_bf16 v[44:47], v[120:123], v[60:63], v[44:47]
    v_mfma_f32_16x16x32_bf16 v[48:51], v[120:123], v[64:67], v[48:51]
    v_mfma_f32_16x16x32_bf16 v[52:55], v[120:123], v[68:71], v[52:55]
    s_waitcnt vmcnt(6) lgkmcnt(0)
    v_mfma_f32_16x16x32_bf16 v[8:11], v[124:127], v[72:75], v[8:11]
    ds_read_b128 v[56:59], v5 offset:0
    v_mfma_f32_16x16x32_bf16 v[12:15], v[124:127], v[76:79], v[12:15]
    v_mfma_f32_16x16x32_bf16 v[16:19], v[124:127], v[80:83], v[16:19]
    ds_read_b128 v[60:63], v5 offset:1024
    v_mfma_f32_16x16x32_bf16 v[20:23], v[124:127], v[84:87], v[20:23]
    v_mfma_f32_16x16x32_bf16 v[24:27], v[128:131], v[72:75], v[24:27]
    ds_read_b128 v[64:67], v5 offset:2048
    v_mfma_f32_16x16x32_bf16 v[28:31], v[128:131], v[76:79], v[28:31]
    v_mfma_f32_16x16x32_bf16 v[32:35], v[128:131], v[80:83], v[32:35]
    ds_read_b128 v[68:71], v5 offset:3072
    v_mfma_f32_16x16x32_bf16 v[36:39], v[128:131], v[84:87], v[36:39]
    v_mfma_f32_16x16x32_bf16 v[40:43], v[132:135], v[72:75], v[40:43]
    v_mfma_f32_16x16x32_bf16 v[44:47], v[132:135], v[76:79], v[44:47]
    v_mfma_f32_16x16x32_bf16 v[48:51], v[132:135], v[80:83], v[48:51]
    v_mfma_f32_16x16x32_bf16 v[52:55], v[132:135], v[84:87], v[52:55]
    s_waitcnt vmcnt(3) lgkmcnt(0)
    v_mfma_f32_16x16x32_bf16 v[8:11], v[136:139], v[56:59], v[8:11]
    ds_read_b128 v[72:75], v5 offset:4096
    v_mfma_f32_16x16x32_bf16 v[12:15], v[136:139], v[60:63], v[12:15]
    v_mfma_f32_16x16x32_bf16 v[16:19], v[136:139], v[64:67], v[16:19]
    ds_read_b128 v[76:79], v5 offset:5120
    v_mfma_f32_16x16x32_bf16 v[20:23], v[136:139], v[68:71], v[20:23]
    v_mfma_f32_16x16x32_bf16 v[24:27], v[140:143], v[56:59], v[24:27]
    ds_read_b128 v[80:83], v5 offset:6144
    v_mfma_f32_16x16x32_bf16 v[28:31], v[140:143], v[60:63], v[28:31]
    v_mfma_f32_16x16x32_bf16 v[32:35], v[140:143], v[64:67], v[32:35]
    ds_read_b128 v[84:87], v5 offset:7168
    v_mfma_f32_16x16x32_bf16 v[36:39], v[140:143], v[68:71], v[36:39]
    v_mfma_f32_16x16x32_bf16 v[40:43], v[144:147], v[56:59], v[40:43]
    v_mfma_f32_16x16x32_bf16 v[44:47], v[144:147], v[60:63], v[44:47]
    v_mfma_f32_16x16x32_bf16 v[48:51], v[144:147], v[64:67], v[48:51]
    v_mfma_f32_16x16x32_bf16 v[52:55], v[144:147], v[68:71], v[52:55]
    s_waitcnt vmcnt(0) lgkmcnt(0)
    v_mfma_f32_16x16x32_bf16 v[8:11], v[88:91], v[72:75], v[8:11]
    v_mfma_f32_16x16x32_bf16 v[12:15], v[88:91], v[76:79], v[12:15]
    v_mfma_f32_16x16x32_bf16 v[16:19], v[88:91], v[80:83], v[16:19]
    v_mfma_f32_16x16x32_bf16 v[20:23], v[88:91], v[84:87], v[20:23]
    v_mfma_f32_16x16x32_bf16 v[24:27], v[92:95], v[72:75], v[24:27]
    v_mfma_f32_16x16x32_bf16 v[28:31], v[92:95], v[76:79], v[28:31]
    v_mfma_f32_16x16x32_bf16 v[32:35], v[92:95], v[80:83], v[32:35]
    v_mfma_f32_16x16x32_bf16 v[36:39], v[92:95], v[84:87], v[36:39]
    v_mfma_f32_16x16x32_bf16 v[40:43], v[96:99], v[72:75], v[40:43]
    v_mfma_f32_16x16x32_bf16 v[44:47], v[96:99], v[76:79], v[44:47]
    v_mfma_f32_16x16x32_bf16 v[48:51], v[96:99], v[80:83], v[48:51]
    v_mfma_f32_16x16x32_bf16 v[52:55], v[96:99], v[84:87], v[52:55]
    s_setprio 0
    s_mul_i32 s36, s24, 2359296
    s_mul_i32 s37, s25, 12
    s_add_u32 s37, s37, s3
    s_mul_i32 s37, s37, 6144
    s_add_u32 s36, s36, s37
    s_add_u32 s36, s36, 17825792
    s_add_u32 s37, s36, 4096
    s_and_b32 s60, s3, 3
    s_mul_i32 s62, s60, 6
    s_mul_i32 s63, s24, 3
    s_sub_u32 s62, s62, s63
    s_mul_i32 s63, s27, 3072
    v_add_u32 v2, s63, v1
    v_cvt_pk_bf16_f32 v56, v8, v9
    v_cvt_pk_bf16_f32 v57, v10, v11
    v_cvt_pk_bf16_f32 v58, v12, v13
    v_cvt_pk_bf16_f32 v59, v14, v15
    s_add_u32 s63, s62, 0
    s_cmp_lt_u32 s63, 3
    s_cbranch_scc1 C_loc_19
    buffer_store_dwordx4 v[56:59], v1, s[4:7], s36 offen offset:0 sc1
    s_branch C_nx_20
C_loc_19:
    s_lshl_b32 s63, s63, 10
    v_add_u32 v3, s63, v2
    ds_write_b128 v3, v[56:59] offset:0
C_nx_20:
    v_cvt_pk_bf16_f32 v60, v16, v17
    v_cvt_pk_bf16_f32 v61, v18, v19
    v_cvt_pk_bf16_f32 v62, v20, v21
    v_cvt_pk_bf16_f32 v63, v22, v23
    s_add_u32 s63, s62, 1
    s_cmp_lt_u32 s63, 3
    s_cbranch_scc1 C_loc_21
    buffer_store_dwordx4 v[60:63], v1, s[4:7], s36 offen offset:1024 sc1
    s_branch C_nx_22
C_loc_21:
    s_lshl_b32 s63, s63, 10
    v_add_u32 v3, s63, v2
    ds_write_b128 v3, v[60:63] offset:0
C_nx_22:
    v_cvt_pk_bf16_f32 v64, v24, v25
    v_cvt_pk_bf16_f32 v65, v26, v27
    v_cvt_pk_bf16_f32 v66, v28, v29
    v_cvt_pk_bf16_f32 v67, v30, v31
    s_add_u32 s63, s62, 2
    s_cmp_lt_u32 s63, 3
    s_cbranch_scc1 C_loc_23
    buffer_store_dwordx4 v[64:67], v1, s[4:7], s36 offen offset:2048 sc1
    s_branch C_nx_24
C_loc_23:
    s_lshl_b32 s63, s63, 10
    v_add_u32 v3, s63, v2
    ds_write_b128 v3, v[64:67] offset:0
C_nx_24:
    v_cvt_pk_bf16_f32 v68, v32, v33
    v_cvt_pk_bf16_f32 v69, v34, v35
    v_cvt_pk_bf16_f32 v70, v36, v37
    v_cvt_pk_bf16_f32 v71, v38, v39
    s_add_u32 s63, s62, 3
    s_cmp_lt_u32 s63, 3
    s_cbranch_scc1 C_loc_25
    buffer_store_dwordx4 v[68:71], v1, s[4:7], s36 offen offset:3072 sc1
    s_branch C_nx_26
C_loc_25:
    s_lshl_b32 s63, s63, 10
    v_add_u32 v3, s63, v2
    ds_write_b128 v3, v[68:71] offset:0
C_nx_26:
    v_cvt_pk_bf16_f32 v72, v40, v41
    v_cvt_pk_bf16_f32 v73, v42, v43
    v_cvt_pk_bf16_f32 v74, v44, v45
    v_cvt_pk_bf16_f32 v75, v46, v47
    s_add_u32 s63, s62, 4
    s_cmp_lt_u32 s63, 3
    s_cbranch_scc1 C_loc_27
    buffer_store_dwordx4 v[72:75], v1, s[4:7], s37 offen offset:0 sc1
    s_branch C_nx_28
C_loc_27:
    s_lshl_b32 s63, s63, 10
    v_add_u32 v3, s63, v2
    ds_write_b128 v3, v[72:75] offset:0
C_nx_28:
    v_cvt_pk_bf16_f32 v76, v48, v49
    v_cvt_pk_bf16_f32 v77, v50, v51
    v_cvt_pk_bf16_f32 v78, v52, v53
    v_cvt_pk_bf16_f32 v79, v54, v55
    s_add_u32 s63, s62, 5
    s_cmp_lt_u32 s63, 3
    s_cbranch_scc1 C_loc_29
    buffer_store_dwordx4 v[76:79], v1, s[4:7], s37 offen offset:1024 sc1
    s_branch C_nx_30
C_loc_29:
    s_lshl_b32 s63, s63, 10
    v_add_u32 v3, s63, v2
    ds_write_b128 v3, v[76:79] offset:0
C_nx_30:
    s_mov_b32 s8, s52
    s_and_b32 s9, s53, 0xffff
    s_mov_b32 s10, 1152
    s_mov_b32 s11, 0x20000
    s_mov_b32 s12, s54
    s_and_b32 s13, s55, 0xffff
    s_mov_b32 s14, 2359296
    s_mov_b32 s15, 0x20000
    s_lshl_b32 s59, s27, 2
    v_add_u32 v6, s59, v6
    s_lshl_b32 s59, s27, 5
    s_mul_i32 s27, s27, 24
    s_mul_i32 s31, s24, 3
    s_add_u32 s27, s27, s31
    s_and_b32 s60, s3, 3
    s_min_u32 s31, s60, 2
    s_add_u32 s27, s27, s31
    s_mul_i32 s56, s25, 72
    s_add_u32 s56, s56, s27
    s_lshl_b32 s56, s56, 10
    s_mov_b32 s26, s25
    s_lshr_b32 s31, s27, 1
    s_and_b32 s32, s27, 1
    v_lshrrev_b32 v7, 4, v0
    v_mov_b32 v87, v2
    v_lshlrev_b32 v2, 4, v7
    s_lshl_b32 s29, s31, 6
    s_add_u32 s29, s29, 11520
    buffer_load_dwordx4 v[46:49], v2, s[4:7], s29 offen
    v_lshlrev_b32 v3, 3, v7
    s_lshl_b32 s29, s31, 5
    buffer_load_dwordx2 v[54:55], v3, s[8:11], s29 offen
    v_and_b32 v5, 1, v7
    v_and_b32 v4, 15, v0
    v_lshl_add_u32 v4, v5, 4, v4
    v_mul_u32_u24 v4, 1152, v4
    v_lshrrev_b32 v5, 1, v7
    v_lshl_add_u32 v4, v5, 4, v4
    s_mul_i32 s30, s26, 73728
    s_mul_i32 s29, s32, 36864
    s_add_u32 s30, s30, s29
    s_lshl_b32 s29, s31, 5
    s_add_u32 s30, s30, s29
    s_mul_i32 s33, s26, 18
    s_lshr_b32 s29, s31, 1
    s_add_u32 s33, s33, s29
    s_lshl_b32 s33, s33, 1
    s_add_u32 s33, s33, s32
    s_lshl_b32 s33, s33, 11
    s_and_b32 s29, s31, 1
    s_lshl_b32 s29, s29, 3
    s_add_u32 s33, s33, s29
    s_add_u32 s33, s33, 4849664
    s_waitcnt vmcnt(0) lgkmcnt(0)
    s_mov_b64 exec, 1
    v_mov_b32 v8, 1
    ds_add_rtn_u32 v9, v6, v8 offset:16
    s_mov_b64 exec, -1
    s_waitcnt lgkmcnt(0)
    v_readfirstlane_b32 s38, v9
    s_mov_b32 s39, 1048576
    s_cmp_lg_u32 s38, 3
    s_cbranch_scc1 C_wl
    s_lshl_b32 s57, s25, 7
    s_add_u32 s57, s57, s59
    s_add_u32 s57, s57, 81920
    s_lshl_b32 s58, s24, 2
    v_mov_b32 v9, s58
    v_mov_b32 v8, 1
    s_mov_b64 exec, 1
    buffer_store_dword v8, v9, s[4:7], s57 offen sc1
    s_mov_b64 exec, -1
    v_and_b32 v9, 7, v0
    v_lshlrev_b32 v9, 2, v9
C_pg:
    buffer_load_dword v8, v9, s[4:7], s57 offen sc1
    s_waitcnt vmcnt(0)
    v_cmp_eq_u32 vcc, 0, v8
    s_cbranch_vccz C_pgd
    s_sub_u32 s39, s39, 1
    s_cmp_eq_u32 s39, 0
    s_cbranch_scc1 C_pgd
    s_sleep 2
    s_branch C_pg
C_pgd:
    v_mov_b32 v8, 1
    ds_write_b32 v6, v8 offset:32
    s_cmp_ge_u32 s60, 3
    s_cbranch_scc1 C_fin
    s_branch C_red
C_wl:
    s_cmp_ge_u32 s60, 3
    s_cbranch_scc1 C_fin
C_pl:
    ds_read_b32 v8, v6 offset:32
    s_waitcnt lgkmcnt(0)
    v_readfirstlane_b32 s38, v8
    s_nop 0
    s_cmp_lg_u32 s38, 0
    s_cbranch_scc1 C_red
    s_sub_u32 s39, s39, 1
    s_cmp_eq_u32 s39, 0
    s_cbranch_scc1 C_red
    s_sleep 4
    s_branch C_pl
C_red:
    s_min_u32 s63, s60, 2
    s_lshl_b32 s63, s63, 10
    v_add_u32 v3, s63, v87
    ds_read_b128 v[10:13], v3 offset:0
    s_add_u32 s28, s56, 17825792
    s_add_u32 s63, s24, 1
    s_and_b32 s63, s63, 7
    s_mul_i32 s63, s63, 2359296
    s_add_u32 s63, s63, s28
    buffer_load_dwordx4 v[14:17], v1, s[4:7], s63 offen sc1
    s_add_u32 s63, s24, 2
    s_and_b32 s63, s63, 7
    s_mul_i32 s63, s63, 2359296
    s_add_u32 s63, s63, s28
    buffer_load_dwordx4 v[18:21], v1, s[4:7], s63 offen sc1
    s_add_u32 s63, s24, 3
    s_and_b32 s63, s63, 7
    s_mul_i32 s63, s63, 2359296
    s_add_u32 s63, s63, s28
    buffer_load_dwordx4 v[22:25], v1, s[4:7], s63 offen sc1
    s_add_u32 s63, s24, 4
    s_and_b32 s63, s63, 7
    s_mul_i32 s63, s63, 2359296
    s_add_u32 s63, s63, s28
    buffer_load_dwordx4 v[26:29], v1, s[4:7], s63 offen sc1
    s_add_u32 s63, s24, 5
    s_and_b32 s63, s63, 7
    s_mul_i32 s63, s63, 2359296
    s_add_u32 s63, s63, s28
    buffer_load_dwordx4 v[30:33], v1, s[4:7], s63 offen sc1
    s_add_u32 s63, s24, 6
    s_and_b32 s63, s63, 7
    s_mul_i32 s63, s63, 2359296
    s_add_u32 s63, s63, s28
    buffer_load_dwordx4 v[34:37], v1, s[4:7], s63 offen sc1
    s_add_u32 s63, s24, 7
    s_and_b32 s63, s63, 7
    s_mul_i32 s63, s63, 2359296
    s_add_u32 s63, s63, s28
    buffer_load_dwordx4 v[38:41], v1, s[4:7], s63 offen sc1
    v_mov_b32 v42, v162
    v_mov_b32 v43, v163
    v_mov_b32 v44, v164
    v_mov_b32 v45, v165
    s_waitcnt lgkmcnt(0)
    s_waitcnt vmcnt(7)
    v_lshlrev_b32 v60, 16, v10
    v_and_b32 v61, 0xffff0000, v10
    v_lshlrev_b32 v62, 16, v11
    v_and_b32 v63, 0xffff0000, v11
    v_lshlrev_b32 v64, 16, v12
    v_and_b32 v65, 0xffff0000, v12
    v_lshlrev_b32 v66, 16, v13
    v_and_b32 v67, 0xffff0000, v13
    v_lshlrev_b32 v50, 16, v54
    v_and_b32 v51, 0xffff0000, v54
    v_lshlrev_b32 v52, 16, v55
    v_and_b32 v53, 0xffff0000, v55
    s_waitcnt vmcnt(6)
    v_lshlrev_b32 v68, 16, v14
    v_and_b32 v69, 0xffff0000, v14
    v_lshlrev_b32 v70, 16, v15
    v_and_b32 v71, 0xffff0000, v15
    v_lshlrev_b32 v72, 16, v16
    v_and_b32 v73, 0xffff0000, v16
    v_lshlrev_b32 v74, 16, v17
    v_and_b32 v75, 0xffff0000, v17
    v_pk_add_f32 v[60:61], v[60:61], v[68:69]
    v_pk_add_f32 v[62:63], v[62:63], v[70:71]
    v_pk_add_f32 v[64:65], v[64:65], v[72:73]
    v_pk_add_f32 v[66:67], v[66:67], v[74:75]
    s_waitcnt vmcnt(5)
    v_lshlrev_b32 v68, 16, v18
    v_and_b32 v69, 0xffff0000, v18
    v_lshlrev_b32 v70, 16, v19
    v_and_b32 v71, 0xffff0000, v19
    v_lshlrev_b32 v72, 16, v20
    v_and_b32 v73, 0xffff0000, v20
    v_lshlrev_b32 v74, 16, v21
    v_and_b32 v75, 0xffff0000, v21
    v_pk_add_f32 v[60:61], v[60:61], v[68:69]
    v_pk_add_f32 v[62:63], v[62:63], v[70:71]
    v_pk_add_f32 v[64:65], v[64:65], v[72:73]
    v_pk_add_f32 v[66:67], v[66:67], v[74:75]
    s_waitcnt vmcnt(4)
    v_lshlrev_b32 v68, 16, v22
    v_and_b32 v69, 0xffff0000, v22
    v_lshlrev_b32 v70, 16, v23
    v_and_b32 v71, 0xffff0000, v23
    v_lshlrev_b32 v72, 16, v24
    v_and_b32 v73, 0xffff0000, v24
    v_lshlrev_b32 v74, 16, v25
    v_and_b32 v75, 0xffff0000, v25
    v_pk_add_f32 v[60:61], v[60:61], v[68:69]
    v_pk_add_f32 v[62:63], v[62:63], v[70:71]
    v_pk_add_f32 v[64:65], v[64:65], v[72:73]
    v_pk_add_f32 v[66:67], v[66:67], v[74:75]
    s_waitcnt vmcnt(3)
    v_lshlrev_b32 v68, 16, v26
    v_and_b32 v69, 0xffff0000, v26
    v_lshlrev_b32 v70, 16, v27
    v_and_b32 v71, 0xffff0000, v27
    v_lshlrev_b32 v72, 16, v28
    v_and_b32 v73, 0xffff0000, v28
    v_lshlrev_b32 v74, 16, v29
    v_and_b32 v75, 0xffff0000, v29
    v_pk_add_f32 v[60:61], v[60:61], v[68:69]
    v_pk_add_f32 v[62:63], v[62:63], v[70:71]
    v_pk_add_f32 v[64:65], v[64:65], v[72:73]
    v_pk_add_f32 v[66:67], v[66:67], v[74:75]
    s_waitcnt vmcnt(2)
    v_lshlrev_b32 v68, 16, v30
    v_and_b32 v69, 0xffff0000, v30
    v_lshlrev_b32 v70, 16, v31
    v_and_b32 v71, 0xffff0000, v31
    v_lshlrev_b32 v72, 16, v32
    v_and_b32 v73, 0xffff0000, v32
    v_lshlrev_b32 v74, 16, v33
    v_and_b32 v75, 0xffff0000, v33
    v_pk_add_f32 v[60:61], v[60:61], v[68:69]
    v_pk_add_f32 v[62:63], v[62:63], v[70:71]
    v_pk_add_f32 v[64:65], v[64:65], v[72:73]
    v_pk_add_f32 v[66:67], v[66:67], v[74:75]
    s_waitcnt vmcnt(1)
    v_lshlrev_b32 v68, 16, v34
    v_and_b32 v69, 0xffff0000, v34
    v_lshlrev_b32 v70, 16, v35
    v_and_b32 v71, 0xffff0000, v35
    v_lshlrev_b32 v72, 16, v36
    v_and_b32 v73, 0xffff0000, v36
    v_lshlrev_b32 v74, 16, v37
    v_and_b32 v75, 0xffff0000, v37
    v_pk_add_f32 v[60:61], v[60:61], v[68:69]
    v_pk_add_f32 v[62:63], v[62:63], v[70:71]
    v_pk_add_f32 v[64:65], v[64:65], v[72:73]
    v_pk_add_f32 v[66:67], v[66:67], v[74:75]
    s_waitcnt vmcnt(0)
    v_lshlrev_b32 v68, 16, v38
    v_and_b32 v69, 0xffff0000, v38
    v_lshlrev_b32 v70, 16, v39
    v_and_b32 v71, 0xffff0000, v39
    v_lshlrev_b32 v72, 16, v40
    v_and_b32 v73, 0xffff0000, v40
    v_lshlrev_b32 v74, 16, v41
    v_and_b32 v75, 0xffff0000, v41
    v_pk_add_f32 v[60:61], v[60:61], v[68:69]
    v_pk_add_f32 v[62:63], v[62:63], v[70:71]
    v_pk_add_f32 v[64:65], v[64:65], v[72:73]
    v_pk_add_f32 v[66:67], v[66:67], v[74:75]
    v_cvt_pk_bf16_f32 v76, v60, v61
    v_cvt_pk_bf16_f32 v77, v62, v63
    v_cvt_pk_bf16_f32 v78, v64, v65
    v_cvt_pk_bf16_f32 v79, v66, v67
    v_lshlrev_b32 v60, 16, v76
    v_and_b32 v61, 0xffff0000, v76
    v_lshlrev_b32 v62, 16, v77
    v_and_b32 v63, 0xffff0000, v77
    v_lshlrev_b32 v64, 16, v78
    v_and_b32 v65, 0xffff0000, v78
    v_lshlrev_b32 v66, 16, v79
    v_and_b32 v67, 0xffff0000, v79
    v_pk_add_f32 v[60:61], v[60:61], v[50:51]
    v_pk_add_f32 v[62:63], v[62:63], v[52:53]
    v_pk_add_f32 v[64:65], v[64:65], v[50:51]
    v_pk_add_f32 v[66:67], v[66:67], v[52:53]
    v_cvt_pk_bf16_f32 v76, v60, v61
    v_cvt_pk_bf16_f32 v77, v62, v63
    v_cvt_pk_bf16_f32 v78, v64, v65
    v_cvt_pk_bf16_f32 v79, v66, v67
    v_lshlrev_b32 v60, 16, v76
    v_and_b32 v61, 0xffff0000, v76
    v_lshlrev_b32 v62, 16, v77
    v_and_b32 v63, 0xffff0000, v77
    v_lshlrev_b32 v64, 16, v78
    v_and_b32 v65, 0xffff0000, v78
    v_lshlrev_b32 v66, 16, v79
    v_and_b32 v67, 0xffff0000, v79
    v_pk_mul_f32 v[60:61], v[60:61], v[46:47]
    v_pk_mul_f32 v[62:63], v[62:63], v[48:49]
    v_pk_mul_f32 v[64:65], v[64:65], v[46:47]
    v_pk_mul_f32 v[66:67], v[66:67], v[48:49]
    v_cvt_pk_bf16_f32 v76, v60, v61
    v_cvt_pk_bf16_f32 v77, v62, v63
    v_cvt_pk_bf16_f32 v78, v64, v65
    v_cvt_pk_bf16_f32 v79, v66, v67
    v_lshlrev_b32 v60, 16, v76
    v_and_b32 v61, 0xffff0000, v76
    v_lshlrev_b32 v62, 16, v77
    v_and_b32 v63, 0xffff0000, v77
    v_lshlrev_b32 v64, 16, v78
    v_and_b32 v65, 0xffff0000, v78
    v_lshlrev_b32 v66, 16, v79
    v_and_b32 v67, 0xffff0000, v79
    s_waitcnt vmcnt(0)
    v_lshlrev_b32 v68, 16, v42
    v_and_b32 v69, 0xffff0000, v42
    v_lshlrev_b32 v70, 16, v43
    v_and_b32 v71, 0xffff0000, v43
    v_lshlrev_b32 v72, 16, v44
    v_and_b32 v73, 0xffff0000, v44
    v_lshlrev_b32 v74, 16, v45
    v_and_b32 v75, 0xffff0000, v45
    v_pk_add_f32 v[60:61], v[60:61], v[68:69]
    v_pk_add_f32 v[62:63], v[62:63], v[70:71]
    v_pk_add_f32 v[64:65], v[64:65], v[72:73]
    v_pk_add_f32 v[66:67], v[66:67], v[74:75]
    v_cvt_pk_bf16_f32 v76, v60, v61
    v_cvt_pk_bf16_f32 v77, v62, v63
    v_cvt_pk_bf16_f32 v78, v64, v65
    v_cvt_pk_bf16_f32 v79, v66, v67
    s_nop 0
    v_permlane16_swap_b32 v76, v78
    v_permlane16_swap_b32 v77, v79
    buffer_store_dwordx4 v[76:79], v4, s[12:15], s30 offen
C_fin:
C_done:
    s_endpgm
text_end:
.section .rodata,"a"
.p2align 6
.amdhsa_kernel front_kernel
  .amdhsa_next_free_vgpr 128
  .amdhsa_next_free_sgpr 102
  .amdhsa_accum_offset 128
  .amdhsa_group_segment_fixed_size 0
  .amdhsa_kernarg_size 152
  .amdhsa_user_sgpr_count 2
  .amdhsa_user_sgpr_kernarg_segment_ptr 1
  .amdhsa_system_sgpr_workgroup_id_x 1
.end_amdhsa_kernel
.p2align 6
.amdhsa_kernel mlp_kernel
  .amdhsa_next_free_vgpr 167
  .amdhsa_next_free_sgpr 66
  .amdhsa_accum_offset 168
  .amdhsa_group_segment_fixed_size 0
  .amdhsa_kernarg_size 152
  .amdhsa_user_sgpr_count 2
  .amdhsa_user_sgpr_kernarg_segment_ptr 1
  .amdhsa_system_sgpr_workgroup_id_x 1
.end_amdhsa_kernel
```
